```python
import torch

def _softmax(x, axis=-1):
    return torch.softmax(x, dim=axis)
def _gelu(x):
    return torch.nn.functional.gelu(x, approximate="tanh")
def _silu(x):
    return torch.nn.functional.silu(x)
def _sigmoid(x):
    return torch.sigmoid(x)
def _layernorm(x, axis=-1, eps=1e-5):
    m = x.mean(dim=axis, keepdim=True)
    v = x.var(dim=axis, keepdim=True, unbiased=False)
    return (x - m) / torch.sqrt(v + eps)
def _scatter_add(tgt, idx, src, axis=0):
    return tgt.clone().index_add_(axis, idx, src)
def _segment_sum(src, seg, n):
    out = torch.zeros((n,) + src.shape[1:], dtype=src.dtype)
    return out.index_add_(0, seg, src)
def _pad(x, pw):
    flat = tuple(v for pair in reversed(pw) for v in pair)
    return torch.nn.functional.pad(x, flat)

kernel_name = 'recurrent_scan__compressed_kv_cla__geglu_ffn__decode'

def setup_inputs():

    _w = (lambda a: (lambda t: t.to(torch.bfloat16) if t.is_floating_point() else t)(torch.as_tensor(a)))
    def _A_setup():
        B, H, Sq, Sk, D, M = 2, 32, 1, 4096, 128, 576
        Dc = 4 * D
        return {
            "x": _w((lambda *s: torch.randn(*s, dtype=torch.bfloat16) * 0.05)(B, Sq, M)),
            "c_kv": _w((lambda *s: torch.randn(*s, dtype=torch.bfloat16) * 0.2)(B, Sk, Dc)),
            "w_q": _w((lambda *s: torch.randn(*s, dtype=torch.bfloat16) * 3.2)(M, H, D) * (M ** -0.5)),
            "w_uk": _w((lambda *s: torch.randn(*s, dtype=torch.bfloat16) * 3.2)(Dc, H, D) * (Dc ** -0.5)),
            "w_uv": _w((lambda *s: torch.randn(*s, dtype=torch.bfloat16) * 0.2)(Dc, H, D) * (Dc ** -0.5)),
            "w_o": _w((lambda *s: torch.randn(*s, dtype=torch.bfloat16) * 0.2)(H, D, M) * ((H * D) ** -0.5)),
        }
    _A_in = _A_setup()

    def _B_setup():
        B, S, D, F = 2, 1, 576, 4608
        return {
            "x": _w((lambda *s: torch.randn(*s, dtype=torch.bfloat16) * 0.05)(B, S, D)),
            "w_gate": _w((lambda *s: torch.randn(*s, dtype=torch.bfloat16) * 0.1)(D, F)),
            "w_up": _w((lambda *s: torch.randn(*s, dtype=torch.bfloat16) * 0.1)(D, F)),
            "w_down": _w((lambda *s: torch.randn(*s, dtype=torch.bfloat16) * 0.1)(F, D)),
        }
    _B_in = _B_setup()

    return {
        "A_x": _A_in["x"],
        "A_c_kv": _A_in["c_kv"],
        "A_w_q": _A_in["w_q"],
        "A_w_uk": _A_in["w_uk"],
        "A_w_uv": _A_in["w_uv"],
        "A_w_o": _A_in["w_o"],
        "B_x": _B_in["x"],
        "B_w_gate": _B_in["w_gate"],
        "B_w_up": _B_in["w_up"],
        "B_w_down": _B_in["w_down"],
    }

def reference(A_x, A_c_kv, A_w_q, A_w_uk, A_w_uv, A_w_o, B_x, B_w_gate, B_w_up, B_w_down):
    def _A_ref(x, c_kv, w_q, w_uk, w_uv, w_o):
        B, Sq, M = x.shape[0], x.shape[1], x.shape[2]
        Sk = c_kv.shape[1]
        H, D = w_q.shape[1], w_q.shape[2]
        q = torch.einsum("bqm,mhd->bhqd", x, w_q)
        k = torch.einsum("bkc,chd->bhkd", c_kv, w_uk)
        v = torch.einsum("bkc,chd->bhkd", c_kv, w_uv)
        scores = torch.einsum("bhqd,bhkd->bhqk", q, k) * (D ** -0.5)
        off = Sk - Sq
        qi = torch.arange(Sq)[:, None]
        kj = torch.arange(Sk)[None, :]
        cmask = kj <= (qi + off)
        scores = torch.where(cmask[None, None], scores, -1e9)
        p = _softmax(scores, axis=-1)
        ctx = torch.einsum("bhqk,bhkd->bhqd", p, v)
        return torch.einsum("bhqd,hdm->bqm", ctx, w_o)

    def _B_ref(x, w_gate, w_up, w_down):
        return (_gelu(x @ w_gate) * (x @ w_up)) @ w_down

    x = A_x
    xn = _layernorm(x, axis=-1)
    s = _A_ref(xn, A_c_kv, A_w_q, A_w_uk, A_w_uv, A_w_o)
    g = _silu(_B_ref(xn, B_w_gate, B_w_up, B_w_down))
    return x + s * g
```

```asm
; @launch grid=(256,1,1) block=(256,1,1) lds=155648
.amdgcn_target "amdgcn-amd-amdhsa--gfx950"
.text
.globl recurrent_scan__compressed_kv_cla__geglu_ffn__decode_kernel
.p2align 8
.type recurrent_scan__compressed_kv_cla__geglu_ffn__decode_kernel,@function
recurrent_scan__compressed_kv_cla__geglu_ffn__decode_kernel:
    s_cmp_ge_u32 s2, 256
    s_cbranch_scc1 L_end
    s_load_dwordx2 s[28:29], s[0:1], 16
    s_mov_b32 s30, 4718592
    s_mov_b32 s31, 0x20000
    s_load_dwordx2 s[36:37], s[0:1], 8
    s_mov_b32 s38, 8388608
    s_mov_b32 s39, 0x20000
    s_load_dwordx2 s[24:25], s[0:1], 0
    s_mov_b32 s26, 2304
    s_mov_b32 s27, 0x20000
    s_load_dwordx2 s[32:33], s[0:1], 24
    s_mov_b32 s34, 4194304
    s_mov_b32 s35, 0x20000
    s_load_dwordx2 s[16:17], s[0:1], 96
    s_mov_b32 s18, 16777216
    s_mov_b32 s19, 0x20000
    s_lshr_b32 s10, s2, 3
    s_and_b32 s9, s2, 7
    v_lshrrev_b32 v7, 6, v0
    v_and_b32 v1, 63, v0
    v_readfirstlane_b32 s6, v7
    s_and_b32 s11, s10, 15
    s_lshl_b32 s12, s9, 4
    s_add_u32 s12, s12, s11
    s_lshr_b32 s7, s12, 2
    s_and_b32 s8, s11, 3
    s_getpc_b64 s[4:5]
L_pc:
    s_and_b32 s3, s10, 15
    s_lshl_b32 s3, s3, 2
    s_add_u32 s3, s3, s6
    s_mul_i32 s3, s3, 384
    v_lshl_add_u32 v7, v1, 6, s3
    v_min_u32 v7, L_end-L_pc, v7
    s_mov_b64 exec, 63
    global_load_dword v9, v7, s[4:5]
    s_mov_b64 exec, -1
    v_and_b32 v2, 15, v1
    v_lshrrev_b32 v3, 4, v1
    v_lshlrev_b32 v6, 4, v1
    s_cmp_ge_u32 s10, 16
    s_cbranch_scc1 L_GB
    v_lshlrev_b32 v7, 5, v3
    v_lshlrev_b32 v8, 4, v2
    v_xor_b32 v7, v7, v8
    v_lshl_add_u32 v17, v3, 13, v7
    s_and_b32 s3, s6, 1
    s_lshl_b32 s3, s3, 7
    v_xor_b32 v13, s3, v17
    v_xor_b32 v14, 0x80, v13
    s_lshl_b32 s46, s7, 8
    s_mul_i32 s44, s8, 1179648
    s_mul_i32 s3, s6, 229376
    s_add_u32 s44, s44, s3
    s_add_u32 s44, s44, s46
    s_mul_i32 s45, s6, 7168
    s_add_u32 s45, s45, 118784
    s_lshl_b32 s48, s7, 13
    s_lshl_b32 s3, s6, 11
    s_add_u32 s48, s48, s3
    s_add_u32 s48, s48, 2097152
    s_lshl_b32 s3, s8, 8
    s_add_u32 s49, s48, s3
    v_lshrrev_b32 v7, 5, v1
    v_mul_u32_u24 v7, 1152, v7
    v_and_b32 v8, 31, v1
    v_lshl_add_u32 v12, v8, 3, v7
    v_lshl_add_u32 v16, v8, 2, v7
    s_waitcnt lgkmcnt(0)
    s_add_u32 s4, s16, 4128768
    s_addc_u32 s5, s17, 0
    s_load_dwordx2 s[60:61], s[4:5], 0
    s_cmp_eq_u32 s6, 0
    s_cbranch_scc0 Lw_1
    buffer_load_dwordx2 v[24:25], v12, s[24:27], 0 offen offset:0
    buffer_load_dwordx2 v[26:27], v12, s[24:27], 0 offen offset:256
    buffer_load_dwordx2 v[28:29], v12, s[24:27], 0 offen offset:512
    buffer_load_dwordx2 v[30:31], v12, s[24:27], 0 offen offset:768
    buffer_load_dword v32, v16, s[24:27], 0 offen offset:1024
    s_add_u32 m0, s45, 0
    s_nop 0
    buffer_load_dwordx4 v13, s[28:31], s44 offen nt lds
    s_add_u32 m0, s45, 1024
    s_add_u32 s44, s44, 32768
    buffer_load_dwordx4 v14, s[28:31], s44 offen nt lds
    s_add_u32 m0, s45, 2048
    s_add_u32 s44, s44, 32768
    buffer_load_dwordx4 v13, s[28:31], s44 offen nt lds
    s_add_u32 m0, s45, 3072
    s_add_u32 s44, s44, 32768
    buffer_load_dwordx4 v14, s[28:31], s44 offen nt lds
    s_add_u32 m0, s45, 4096
    s_add_u32 s44, s44, 32768
    buffer_load_dwordx4 v13, s[28:31], s44 offen nt lds
    s_add_u32 m0, s45, 5120
    s_add_u32 s44, s44, 32768
    buffer_load_dwordx4 v14, s[28:31], s44 offen nt lds
    s_add_u32 m0, s45, 6144
    s_add_u32 s44, s44, 32768
    buffer_load_dwordx4 v13, s[28:31], s44 offen nt lds
    v_lshlrev_b32 v7, 5, v1
    buffer_load_dword v9, v7, s[16:19], s48 offen sc1
    v_lshrrev_b32 v4, 2, v2
    v_and_b32 v5, 3, v1
    v_lshlrev_b32 v5, 3, v5
    v_mov_b32 v254, 0xffffff00
    v_mov_b32 v255, 0x00010001
    v_mov_b32 v252, 0x07060302
    v_mov_b32 v251, 2130706432
    v_and_b32 v7, 1, v2
    v_cmp_ne_u32 s[62:63], 0, v7
    v_and_b32 v8, 2, v2
    v_cmp_ne_u32 s[22:23], 0, v8
    v_and_b32 v10, 4, v2
    v_cmp_ne_u32 s[58:59], 0, v10
    v_lshlrev_b32 v7, 7, v7
    v_lshl_add_u32 v7, v8, 5, v7
    v_lshl_add_u32 v7, v3, 4, v7
    v_cmp_gt_u32 vcc, 4, v2
    s_nop 1
    v_cndmask_b32 v247, v251, v7, vcc
    v_lshlrev_b32 v7, 5, v5
    v_lshl_add_u32 v7, v10, 5, v7
    v_lshrrev_b32 v8, 3, v2
    v_lshl_add_u32 v7, v8, 6, v7
    v_lshl_add_u32 v248, v3, 4, v7
    v_and_b32 v7, 1, v3
    v_lshl_add_u32 v250, v7, 2, v4
    v_lshl_add_u32 v249, v250, 5, v5
    v_and_b32 v7, 1, v2
    v_mul_u32_u24 v8, 1152, v7
    v_lshl_add_u32 v81, v3, 3, v8
    s_mul_i32 s3, s8, 288
    v_add_u32 v80, s3, v81
    s_lshl_b32 s3, s6, 6
    v_xor_b32 v10, s3, v249
    v_lshl_add_u32 v8, v3, 2, v4
    v_lshl_add_u32 v10, v8, 8, v10
    v_add_u32 v78, 118784, v10
    v_xor_b32 v79, 32, v78
    v_lshlrev_b32 v8, 8, v7
    v_lshl_add_u32 v8, v3, 4, v8
    v_add_u32 v87, 2560, v8
    v_lshlrev_b32 v7, 15, v7
    v_lshrrev_b32 v8, 1, v2
    v_lshl_add_u32 v7, v8, 5, v7
    v_lshl_add_u32 v7, v3, 3, v7
    v_cmp_gt_u32 vcc, 8, v2
    s_nop 1
    v_cndmask_b32 v88, v251, v7, vcc
    v_lshrrev_b32 v7, 1, v3
    v_and_b32 v8, 7, v2
    v_xor_b32 v7, v7, v8
    v_lshlrev_b32 v7, 5, v7
    v_and_b32 v8, 1, v3
    v_lshl_add_u32 v7, v8, 4, v7
    v_lshl_add_u32 v7, v2, 8, v7
    s_lshl_b32 s3, s6, 14
    s_add_u32 s3, s3, 86016
    v_add_u32 v82, s3, v7
    s_lshl_b32 s50, s12, 8
    s_lshl_b32 s3, s6, 7
    s_add_u32 s50, s50, s3
    s_add_u32 s50, s50, 3538944
    s_mov_b32 s51, 0x3e0293ee
    v_xor_b32 v83, 64, v82
    v_xor_b32 v84, 128, v82
    v_xor_b32 v85, 192, v82
    s_lshl_b32 s3, s6, 6
    s_add_u32 s3, s3, 2560
    v_bfe_u32 v7, v2, 2, 1
    v_lshlrev_b32 v7, 8, v7
    v_lshrrev_b32 v8, 3, v2
    v_lshl_add_u32 v7, v8, 5, v7
    v_lshl_add_u32 v7, v3, 3, v7
    v_add_u32 v86, s3, v7
    s_waitcnt vmcnt(8)
    v_lshlrev_b32 v34, 16, v24
    v_and_b32 v35, 0xffff0000, v24
    v_lshlrev_b32 v36, 16, v25
    v_and_b32 v37, 0xffff0000, v25
    v_lshlrev_b32 v38, 16, v26
    v_and_b32 v39, 0xffff0000, v26
    v_lshlrev_b32 v40, 16, v27
    v_and_b32 v41, 0xffff0000, v27
    v_lshlrev_b32 v42, 16, v28
    v_and_b32 v43, 0xffff0000, v28
    v_lshlrev_b32 v44, 16, v29
    v_and_b32 v45, 0xffff0000, v29
    v_lshlrev_b32 v46, 16, v30
    v_and_b32 v47, 0xffff0000, v30
    v_lshlrev_b32 v48, 16, v31
    v_and_b32 v49, 0xffff0000, v31
    v_lshlrev_b32 v50, 16, v32
    v_and_b32 v51, 0xffff0000, v32
    v_pk_add_f32 v[52:53], v[34:35], v[36:37]
    v_pk_add_f32 v[54:55], v[38:39], v[40:41]
    v_pk_add_f32 v[52:53], v[52:53], v[42:43]
    v_pk_add_f32 v[54:55], v[54:55], v[44:45]
    v_pk_add_f32 v[52:53], v[52:53], v[46:47]
    v_pk_add_f32 v[54:55], v[54:55], v[48:49]
    v_pk_add_f32 v[52:53], v[52:53], v[50:51]
    v_pk_add_f32 v[52:53], v[52:53], v[54:55]
    v_add_f32 v52, v52, v53
    s_nop 1
    v_add_f32_dpp v52, v52, v52 row_ror:8 row_mask:0xf bank_mask:0xf
    s_nop 1
    v_add_f32_dpp v52, v52, v52 row_ror:4 row_mask:0xf bank_mask:0xf
    s_nop 1
    v_add_f32_dpp v52, v52, v52 row_ror:2 row_mask:0xf bank_mask:0xf
    s_nop 1
    v_add_f32_dpp v52, v52, v52 row_ror:1 row_mask:0xf bank_mask:0xf
    v_mov_b32 v53, v52
    s_nop 1
    v_permlane16_swap_b32 v52, v53
    v_add_f32 v52, v52, v53
    v_mul_f32 v52, 0x3ae38e39, v52
    v_cvt_pk_bf16_f32 v54, v52, v52
    v_mov_b32 v53, v52
    v_and_b32 v54, 0xffff0000, v54
    v_mov_b32 v55, v54
    v_pk_add_f32 v[56:57], v[34:35], v[52:53] neg_lo:[0,1] neg_hi:[0,1]
    v_pk_add_f32 v[58:59], v[36:37], v[52:53] neg_lo:[0,1] neg_hi:[0,1]
    v_pk_add_f32 v[60:61], v[38:39], v[52:53] neg_lo:[0,1] neg_hi:[0,1]
    v_pk_add_f32 v[62:63], v[40:41], v[52:53] neg_lo:[0,1] neg_hi:[0,1]
    v_pk_add_f32 v[64:65], v[42:43], v[52:53] neg_lo:[0,1] neg_hi:[0,1]
    v_pk_add_f32 v[66:67], v[44:45], v[52:53] neg_lo:[0,1] neg_hi:[0,1]
    v_pk_add_f32 v[68:69], v[46:47], v[52:53] neg_lo:[0,1] neg_hi:[0,1]
    v_pk_add_f32 v[70:71], v[48:49], v[52:53] neg_lo:[0,1] neg_hi:[0,1]
    v_pk_add_f32 v[72:73], v[50:51], v[52:53] neg_lo:[0,1] neg_hi:[0,1]
    v_pk_mul_f32 v[74:75], v[56:57], v[56:57]
    v_pk_mul_f32 v[76:77], v[58:59], v[58:59]
    v_pk_fma_f32 v[74:75], v[60:61], v[60:61], v[74:75]
    v_pk_fma_f32 v[76:77], v[62:63], v[62:63], v[76:77]
    v_pk_fma_f32 v[74:75], v[64:65], v[64:65], v[74:75]
    v_pk_fma_f32 v[76:77], v[66:67], v[66:67], v[76:77]
    v_pk_fma_f32 v[74:75], v[68:69], v[68:69], v[74:75]
    v_pk_fma_f32 v[76:77], v[70:71], v[70:71], v[76:77]
    v_pk_fma_f32 v[74:75], v[72:73], v[72:73], v[74:75]
    v_pk_add_f32 v[74:75], v[74:75], v[76:77]
    v_add_f32 v74, v74, v75
    v_pk_add_f32 v[56:57], v[34:35], v[54:55] neg_lo:[0,1] neg_hi:[0,1]
    v_pk_add_f32 v[58:59], v[36:37], v[54:55] neg_lo:[0,1] neg_hi:[0,1]
    v_add_f32_dpp v74, v74, v74 row_ror:8 row_mask:0xf bank_mask:0xf
    v_pk_add_f32 v[60:61], v[38:39], v[54:55] neg_lo:[0,1] neg_hi:[0,1]
    v_pk_add_f32 v[62:63], v[40:41], v[54:55] neg_lo:[0,1] neg_hi:[0,1]
    v_add_f32_dpp v74, v74, v74 row_ror:4 row_mask:0xf bank_mask:0xf
    v_pk_add_f32 v[64:65], v[42:43], v[54:55] neg_lo:[0,1] neg_hi:[0,1]
    v_pk_add_f32 v[66:67], v[44:45], v[54:55] neg_lo:[0,1] neg_hi:[0,1]
    v_add_f32_dpp v74, v74, v74 row_ror:2 row_mask:0xf bank_mask:0xf
    v_pk_add_f32 v[68:69], v[46:47], v[54:55] neg_lo:[0,1] neg_hi:[0,1]
    v_pk_add_f32 v[70:71], v[48:49], v[54:55] neg_lo:[0,1] neg_hi:[0,1]
    v_add_f32_dpp v74, v74, v74 row_ror:1 row_mask:0xf bank_mask:0xf
    v_pk_add_f32 v[72:73], v[50:51], v[54:55] neg_lo:[0,1] neg_hi:[0,1]
    v_cvt_pk_bf16_f32 v24, v56, v57
    v_mov_b32 v75, v74
    v_cvt_pk_bf16_f32 v25, v58, v59
    v_cvt_pk_bf16_f32 v26, v60, v61
    v_permlane16_swap_b32 v74, v75
    v_cvt_pk_bf16_f32 v27, v62, v63
    v_cvt_pk_bf16_f32 v28, v64, v65
    v_add_f32 v74, v74, v75
    v_cvt_pk_bf16_f32 v29, v66, v67
    v_cvt_pk_bf16_f32 v30, v68, v69
    v_mul_f32 v74, 0x3ae38e39, v74
    v_cvt_pk_bf16_f32 v31, v70, v71
    v_cvt_pk_bf16_f32 v32, v72, v73
    v_cvt_pk_bf16_f32 v74, v74, v74
    v_lshlrev_b32 v34, 16, v24
    v_and_b32 v35, 0xffff0000, v24
    v_and_b32 v74, 0xffff0000, v74
    v_lshlrev_b32 v36, 16, v25
    v_and_b32 v37, 0xffff0000, v25
    v_add_f32 v74, 0x3727c5ac, v74
    v_lshlrev_b32 v38, 16, v26
    v_and_b32 v39, 0xffff0000, v26
    v_cvt_pk_bf16_f32 v74, v74, v74
    v_lshlrev_b32 v40, 16, v27
    v_and_b32 v41, 0xffff0000, v27
    v_and_b32 v74, 0xffff0000, v74
    v_lshlrev_b32 v42, 16, v28
    v_and_b32 v43, 0xffff0000, v28
    v_sqrt_f32 v74, v74
    v_lshlrev_b32 v44, 16, v29
    v_and_b32 v45, 0xffff0000, v29
    v_cvt_pk_bf16_f32 v74, v74, v74
    v_lshlrev_b32 v46, 16, v30
    v_and_b32 v47, 0xffff0000, v30
    v_and_b32 v74, 0xffff0000, v74
    v_lshlrev_b32 v48, 16, v31
    v_and_b32 v49, 0xffff0000, v31
    v_rcp_f32 v74, v74
    v_lshlrev_b32 v50, 16, v32
    v_and_b32 v51, 0xffff0000, v32
    v_mov_b32 v75, v74
    v_pk_mul_f32 v[34:35], v[34:35], v[74:75]
    v_pk_mul_f32 v[36:37], v[36:37], v[74:75]
    v_pk_mul_f32 v[38:39], v[38:39], v[74:75]
    v_pk_mul_f32 v[40:41], v[40:41], v[74:75]
    v_pk_mul_f32 v[42:43], v[42:43], v[74:75]
    v_pk_mul_f32 v[44:45], v[44:45], v[74:75]
    v_pk_mul_f32 v[46:47], v[46:47], v[74:75]
    v_pk_mul_f32 v[48:49], v[48:49], v[74:75]
    v_pk_mul_f32 v[50:51], v[50:51], v[74:75]
    v_cvt_pk_bf16_f32 v24, v34, v35
    v_cvt_pk_bf16_f32 v25, v36, v37
    ds_write_b64 v12, v[24:25] offset:0
    v_cvt_pk_bf16_f32 v26, v38, v39
    v_cvt_pk_bf16_f32 v27, v40, v41
    ds_write_b64 v12, v[26:27] offset:256
    v_cvt_pk_bf16_f32 v28, v42, v43
    v_cvt_pk_bf16_f32 v29, v44, v45
    ds_write_b64 v12, v[28:29] offset:512
    v_cvt_pk_bf16_f32 v30, v46, v47
    v_cvt_pk_bf16_f32 v31, v48, v49
    ds_write_b64 v12, v[30:31] offset:768
    v_cvt_pk_bf16_f32 v32, v50, v51
    ds_write_b32 v16, v32 offset:1024
    s_waitcnt vmcnt(1)
    s_branch Lw_2
Lw_1:
    s_add_u32 m0, s45, 0
    s_nop 0
    buffer_load_dwordx4 v13, s[28:31], s44 offen nt lds
    s_add_u32 m0, s45, 1024
    s_add_u32 s44, s44, 32768
    buffer_load_dwordx4 v14, s[28:31], s44 offen nt lds
    s_add_u32 m0, s45, 2048
    s_add_u32 s44, s44, 32768
    buffer_load_dwordx4 v13, s[28:31], s44 offen nt lds
    s_add_u32 m0, s45, 3072
    s_add_u32 s44, s44, 32768
    buffer_load_dwordx4 v14, s[28:31], s44 offen nt lds
    s_add_u32 m0, s45, 4096
    s_add_u32 s44, s44, 32768
    buffer_load_dwordx4 v13, s[28:31], s44 offen nt lds
    s_add_u32 m0, s45, 5120
    s_add_u32 s44, s44, 32768
    buffer_load_dwordx4 v14, s[28:31], s44 offen nt lds
    s_add_u32 m0, s45, 6144
    s_add_u32 s44, s44, 32768
    buffer_load_dwordx4 v13, s[28:31], s44 offen nt lds
    v_lshlrev_b32 v7, 5, v1
    buffer_load_dword v9, v7, s[16:19], s48 offen sc1
    s_sub_u32 s3, s6, 1
    s_mul_i32 s3, s3, 11
    s_lshl_b32 s21, s3, 10
    s_add_u32 s21, s21, 86016
    s_lshl_b32 s47, s3, 15
    s_add_u32 s47, s47, s46
    s_lshl_b32 s46, s8, 20
    s_add_u32 s47, s47, s46
    s_and_b32 s3, s3, 1
    s_lshl_b32 s3, s3, 7
    v_xor_b32 v17, s3, v17
    v_xor_b32 v18, 0x80, v17
    s_add_u32 m0, s21, 0
    s_nop 0
    buffer_load_dwordx4 v17, s[32:35], s47 offen nt lds
    s_add_u32 m0, s21, 1024
    s_add_u32 s47, s47, 32768
    buffer_load_dwordx4 v18, s[32:35], s47 offen nt lds
    s_add_u32 m0, s21, 2048
    s_add_u32 s47, s47, 32768
    buffer_load_dwordx4 v17, s[32:35], s47 offen nt lds
    s_add_u32 m0, s21, 3072
    s_add_u32 s47, s47, 32768
    buffer_load_dwordx4 v18, s[32:35], s47 offen nt lds
    s_add_u32 m0, s21, 4096
    s_add_u32 s47, s47, 32768
    buffer_load_dwordx4 v17, s[32:35], s47 offen nt lds
    s_add_u32 m0, s21, 5120
    s_add_u32 s47, s47, 32768
    buffer_load_dwordx4 v18, s[32:35], s47 offen nt lds
    s_add_u32 m0, s21, 6144
    s_add_u32 s47, s47, 32768
    buffer_load_dwordx4 v17, s[32:35], s47 offen nt lds
    s_add_u32 m0, s21, 7168
    s_add_u32 s47, s47, 32768
    buffer_load_dwordx4 v18, s[32:35], s47 offen nt lds
    v_lshrrev_b32 v4, 2, v2
    v_and_b32 v5, 3, v1
    v_lshlrev_b32 v5, 3, v5
    v_mov_b32 v254, 0xffffff00
    v_mov_b32 v255, 0x00010001
    v_mov_b32 v252, 0x07060302
    v_mov_b32 v251, 2130706432
    v_and_b32 v7, 1, v2
    v_cmp_ne_u32 s[62:63], 0, v7
    v_and_b32 v8, 2, v2
    v_cmp_ne_u32 s[22:23], 0, v8
    v_and_b32 v10, 4, v2
    v_cmp_ne_u32 s[58:59], 0, v10
    v_lshlrev_b32 v7, 7, v7
    v_lshl_add_u32 v7, v8, 5, v7
    v_lshl_add_u32 v7, v3, 4, v7
    v_cmp_gt_u32 vcc, 4, v2
    s_nop 1
    v_cndmask_b32 v247, v251, v7, vcc
    v_lshlrev_b32 v7, 5, v5
    v_lshl_add_u32 v7, v10, 5, v7
    v_lshrrev_b32 v8, 3, v2
    v_lshl_add_u32 v7, v8, 6, v7
    v_lshl_add_u32 v248, v3, 4, v7
    v_and_b32 v7, 1, v3
    v_lshl_add_u32 v250, v7, 2, v4
    v_lshl_add_u32 v249, v250, 5, v5
    v_and_b32 v7, 1, v2
    v_mul_u32_u24 v8, 1152, v7
    v_lshl_add_u32 v81, v3, 3, v8
    s_mul_i32 s3, s8, 288
    v_add_u32 v80, s3, v81
    s_lshl_b32 s3, s6, 6
    v_xor_b32 v10, s3, v249
    v_lshl_add_u32 v8, v3, 2, v4
    v_lshl_add_u32 v10, v8, 8, v10
    v_add_u32 v78, 118784, v10
    v_xor_b32 v79, 32, v78
    v_lshlrev_b32 v8, 8, v7
    v_lshl_add_u32 v8, v3, 4, v8
    v_add_u32 v87, 2560, v8
    v_lshlrev_b32 v7, 15, v7
    v_lshrrev_b32 v8, 1, v2
    v_lshl_add_u32 v7, v8, 5, v7
    v_lshl_add_u32 v7, v3, 3, v7
    v_cmp_gt_u32 vcc, 8, v2
    s_nop 1
    v_cndmask_b32 v88, v251, v7, vcc
    v_lshrrev_b32 v7, 1, v3
    v_and_b32 v8, 7, v2
    v_xor_b32 v7, v7, v8
    v_lshlrev_b32 v7, 5, v7
    v_and_b32 v8, 1, v3
    v_lshl_add_u32 v7, v8, 4, v7
    v_lshl_add_u32 v7, v2, 8, v7
    s_lshl_b32 s3, s6, 14
    s_add_u32 s3, s3, 86016
    v_add_u32 v82, s3, v7
    s_lshl_b32 s50, s12, 8
    s_lshl_b32 s3, s6, 7
    s_add_u32 s50, s50, s3
    s_add_u32 s50, s50, 3538944
    s_mov_b32 s51, 0x3e0293ee
    v_xor_b32 v83, 64, v82
    v_xor_b32 v84, 128, v82
    v_xor_b32 v85, 192, v82
    s_lshl_b32 s3, s6, 6
    s_add_u32 s3, s3, 2560
    v_bfe_u32 v7, v2, 2, 1
    v_lshlrev_b32 v7, 8, v7
    v_lshrrev_b32 v8, 3, v2
    v_lshl_add_u32 v7, v8, 5, v7
    v_lshl_add_u32 v7, v3, 3, v7
    v_add_u32 v86, s3, v7
    s_add_u32 m0, s21, 8192
    s_add_u32 s47, s47, 32768
    buffer_load_dwordx4 v17, s[32:35], s47 offen nt lds
    s_add_u32 m0, s21, 9216
    s_add_u32 s47, s47, 32768
    buffer_load_dwordx4 v18, s[32:35], s47 offen nt lds
    s_waitcnt vmcnt(11)
    s_cmp_eq_u32 s6, 3
    s_cbranch_scc1 Lw_2
    s_add_u32 m0, s21, 10240
    s_add_u32 s47, s47, 32768
    buffer_load_dwordx4 v17, s[32:35], s47 offen nt lds
Lw_2:
    s_load_dwordx2 s[28:29], s[0:1], 56
    s_mov_b32 s30, 5308416
    s_mov_b32 s31, 0x20000
    s_load_dwordx2 s[36:37], s[0:1], 64
    s_mov_b32 s38, 5308416
    s_mov_b32 s39, 0x20000
    s_load_dwordx2 s[32:33], s[0:1], 72
    s_mov_b32 s34, 5308416
    s_mov_b32 s35, 0x20000
    s_mov_b32 s43, 0x20000
    s_waitcnt lgkmcnt(0)
    s_barrier
    ds_read2_b64 v[112:115], v80 offset0:0 offset1:4
    ds_read2_b64 v[116:119], v80 offset0:8 offset1:12
    ds_read2_b64 v[120:123], v80 offset0:16 offset1:20
    ds_read_b64 v[124:125], v80 offset:192
    ds_read_b64_tr_b16 v[132:133], v78 offset:0
    ds_read_b64_tr_b16 v[134:135], v78 offset:4096
    ds_read_b64_tr_b16 v[146:147], v79 offset:0
    ds_read_b64_tr_b16 v[148:149], v79 offset:4096
    ds_read_b64_tr_b16 v[136:137], v78 offset:8192
    ds_read_b64_tr_b16 v[138:139], v78 offset:12288
    ds_read_b64_tr_b16 v[150:151], v79 offset:8192
    ds_read_b64_tr_b16 v[152:153], v79 offset:12288
    ds_read_b64_tr_b16 v[140:141], v78 offset:16384
    ds_read_b64_tr_b16 v[142:143], v78 offset:20480
    ds_read_b64_tr_b16 v[154:155], v79 offset:16384
    ds_read_b64_tr_b16 v[156:157], v79 offset:20480
    s_add_u32 s100, s60, 0x9e3779b1
    s_and_b32 s3, s61, 0x55
    s_lshl_b32 s3, s3, 1
    s_xor_b32 s61, s61, s3
    s_xor_b32 s61, s61, 0x55
    s_and_b32 s61, s61, 0xff
    s_and_b32 s3, s61, 4
    s_lshl_b32 s3, s3, 1
    s_or_b32 s60, s3, 4
    s_lshr_b32 s3, s61, 4
    s_xor_b32 s3, s3, s61
    s_and_b32 s3, s3, 15
    s_cselect_b32 s60, 0, s60
    s_xor_b32 s61, s61, s60
    v_bfe_u32 v236, s100, 0, 8
    v_bfe_u32 v237, s100, 8, 8
    v_bfe_u32 v238, s100, 16, 8
    v_bfe_u32 v239, s100, 24, 8
    s_bfe_u32 s3, s61, 65537
    s_lshl_b32 s3, s3, 16
    s_bfe_u32 s96, s61, 65536
    s_or_b32 s96, s96, s3
    s_bfe_u32 s3, s61, 65539
    s_lshl_b32 s3, s3, 16
    s_bfe_u32 s97, s61, 65538
    s_or_b32 s97, s97, s3
    s_bfe_u32 s3, s61, 65541
    s_lshl_b32 s3, s3, 16
    s_bfe_u32 s98, s61, 65540
    s_or_b32 s98, s98, s3
    s_bfe_u32 s3, s61, 65543
    s_lshl_b32 s3, s3, 16
    s_bfe_u32 s99, s61, 65542
    s_or_b32 s99, s99, s3
    s_waitcnt lgkmcnt(8)
    v_mfma_f32_16x16x32_bf16 v[168:171], v[132:135], v[112:115], 0
    v_mfma_f32_16x16x32_bf16 v[172:175], v[146:149], v[112:115], 0
    ds_read_b64_tr_b16 v[144:145], v78 offset:24576
    ds_read_b64_tr_b16 v[158:159], v79 offset:24576
    s_waitcnt lgkmcnt(6)
    v_mfma_f32_16x16x32_bf16 v[168:171], v[136:139], v[116:119], v[168:171]
    v_mfma_f32_16x16x32_bf16 v[172:175], v[150:153], v[116:119], v[172:175]
    s_waitcnt lgkmcnt(2)
    v_mfma_f32_16x16x32_bf16 v[168:171], v[140:143], v[120:123], v[168:171]
    v_mfma_f32_16x16x32_bf16 v[172:175], v[154:157], v[120:123], v[172:175]
    s_waitcnt lgkmcnt(0)
    v_mfma_f32_16x16x16_bf16 v[168:171], v[144:145], v[124:125], v[168:171]
    v_mfma_f32_16x16x16_bf16 v[172:175], v[158:159], v[124:125], v[172:175]
    s_nop 7
    v_cndmask_b32 v168, v168, v172, s[22:23]
    v_cndmask_b32 v169, v169, v173, s[22:23]
    v_cndmask_b32 v170, v170, v174, s[22:23]
    v_cndmask_b32 v171, v171, v175, s[22:23]
    v_and_or_b32 v168, v168, v254, v236
    v_and_or_b32 v169, v169, v254, v237
    v_and_or_b32 v170, v170, v254, v238
    v_and_or_b32 v171, v171, v254, v239
    buffer_store_dwordx4 v[168:171], v247, s[16:19], s49 offen
    v_and_b32 v7, 1, v3
    v_cmp_eq_u32 vcc, 0, v7
    v_mov_b32 v7, s96
    v_mov_b32 v8, s98
    v_cndmask_b32 v90, v8, v7, vcc
    v_mov_b32 v7, s97
    v_mov_b32 v8, s99
    v_cndmask_b32 v91, v8, v7, vcc
    s_waitcnt vmcnt(2)
    buffer_load_dwordx4 v[92:95], v248, s[16:19], s48 offen offset:0 sc1
    buffer_load_dwordx4 v[96:99], v248, s[16:19], s48 offen offset:1024 sc1
    s_waitcnt vmcnt(3)
    s_barrier
    s_cmp_ge_u32 s6, 2
    s_cbranch_scc1 Lsk_4
    ds_read_b128 a[0:3], v82 offset:0
    ds_read_b128 a[4:7], v83 offset:0
    ds_read_b128 a[8:11], v84 offset:0
    ds_read_b128 a[12:15], v85 offset:0
    ds_read_b128 a[16:19], v82 offset:4096
    ds_read_b128 a[20:23], v83 offset:4096
    ds_read_b128 a[24:27], v84 offset:4096
    ds_read_b128 a[28:31], v85 offset:4096
    ds_read_b128 a[32:35], v82 offset:8192
    ds_read_b128 a[36:39], v83 offset:8192
    ds_read_b128 a[40:43], v84 offset:8192
    ds_read_b128 a[44:47], v85 offset:8192
    ds_read_b128 a[48:51], v82 offset:12288
    ds_read_b128 a[52:55], v83 offset:12288
    ds_read_b128 a[56:59], v84 offset:12288
    ds_read_b128 a[60:63], v85 offset:12288
Lsk_4:
    s_mov_b32 s60, 60000
    s_waitcnt vmcnt(0)
Lp_5:
    v_xor_b32 v7, v236, v92
    v_bitop3_b32 v7, v7, v93, v237 bitop3:0xf6
    v_bitop3_b32 v7, v7, v94, v238 bitop3:0xf6
    v_bitop3_b32 v7, v7, v95, v239 bitop3:0xf6
    v_bitop3_b32 v7, v7, v96, v236 bitop3:0xf6
    v_bitop3_b32 v7, v7, v97, v237 bitop3:0xf6
    v_bitop3_b32 v7, v7, v98, v238 bitop3:0xf6
    v_bitop3_b32 v7, v7, v99, v239 bitop3:0xf6
    v_and_b32 v7, 0xff, v7
    v_cmp_ne_u32 vcc, 0, v7
    s_cbranch_vccz Lok_6
    s_sub_u32 s60, s60, 1
    s_cbranch_scc1 Lok_6
    s_cmp_eq_u32 s60, 59976
    s_cbranch_scc0 Lns_7
    s_add_u32 s3, s49, 720896
    buffer_store_dwordx4 v[168:171], v247, s[16:19], s3 offen sc1
Lns_7:
    s_cmp_le_u32 s60, 59976
    s_cselect_b32 s3, s60, 1
    s_and_b32 s3, s3, 3
    s_cselect_b32 s3, 0, 720896
    v_add_u32 v8, s3, v248
    buffer_load_dwordx4 v[92:95], v8, s[16:19], s48 offen offset:0 sc1
    buffer_load_dwordx4 v[96:99], v8, s[16:19], s48 offen offset:1024 sc1
    s_waitcnt vmcnt(0)
    s_branch Lp_5
Lok_6:
    v_pk_add_f32 v[92:93], v[92:93], v[96:97]
    v_pk_add_f32 v[94:95], v[94:95], v[98:99]
    s_nop 0
    v_add_f32_dpp v92, v92, v92 quad_perm:[1,0,3,2] row_mask:0xf bank_mask:0xf
    v_add_f32_dpp v93, v93, v93 quad_perm:[1,0,3,2] row_mask:0xf bank_mask:0xf
    v_add_f32_dpp v94, v94, v94 quad_perm:[1,0,3,2] row_mask:0xf bank_mask:0xf
    v_add_f32_dpp v95, v95, v95 quad_perm:[1,0,3,2] row_mask:0xf bank_mask:0xf
    v_add_f32_dpp v92, v92, v92 quad_perm:[2,3,0,1] row_mask:0xf bank_mask:0xf
    v_add_f32_dpp v93, v93, v93 quad_perm:[2,3,0,1] row_mask:0xf bank_mask:0xf
    v_add_f32_dpp v94, v94, v94 quad_perm:[2,3,0,1] row_mask:0xf bank_mask:0xf
    v_add_f32_dpp v95, v95, v95 quad_perm:[2,3,0,1] row_mask:0xf bank_mask:0xf
    v_cvt_pk_bf16_f32 v92, v92, v93
    v_cvt_pk_bf16_f32 v93, v94, v95
    ds_write_b64 v86, v[92:93]
    s_waitcnt lgkmcnt(0)
    s_barrier
    s_cmp_ge_u32 s6, 2
    s_cbranch_scc1 Lsk_8
    ds_read_b128 v[92:95], v87 offset:0
    ds_read_b128 v[96:99], v87 offset:64
    ds_read_b128 v[100:103], v87 offset:128
    ds_read_b128 v[104:107], v87 offset:192
    s_waitcnt lgkmcnt(3)
    v_mfma_f32_16x16x32_bf16 v[112:115], a[0:3], v[92:95], 0
    v_mfma_f32_16x16x32_bf16 v[116:119], a[16:19], v[92:95], 0
    v_mfma_f32_16x16x32_bf16 v[120:123], a[32:35], v[92:95], 0
    v_mfma_f32_16x16x32_bf16 v[124:127], a[48:51], v[92:95], 0
    s_waitcnt lgkmcnt(2)
    v_mfma_f32_16x16x32_bf16 v[112:115], a[4:7], v[96:99], v[112:115]
    v_mfma_f32_16x16x32_bf16 v[116:119], a[20:23], v[96:99], v[116:119]
    v_mfma_f32_16x16x32_bf16 v[120:123], a[36:39], v[96:99], v[120:123]
    v_mfma_f32_16x16x32_bf16 v[124:127], a[52:55], v[96:99], v[124:127]
    s_waitcnt lgkmcnt(1)
    v_mfma_f32_16x16x32_bf16 v[112:115], a[8:11], v[100:103], v[112:115]
    v_mfma_f32_16x16x32_bf16 v[116:119], a[24:27], v[100:103], v[116:119]
    v_mfma_f32_16x16x32_bf16 v[120:123], a[40:43], v[100:103], v[120:123]
    v_mfma_f32_16x16x32_bf16 v[124:127], a[56:59], v[100:103], v[124:127]
    s_waitcnt lgkmcnt(0)
    v_mfma_f32_16x16x32_bf16 v[112:115], a[12:15], v[104:107], v[112:115]
    v_mfma_f32_16x16x32_bf16 v[116:119], a[28:31], v[104:107], v[116:119]
    v_mfma_f32_16x16x32_bf16 v[120:123], a[44:47], v[104:107], v[120:123]
    v_mfma_f32_16x16x32_bf16 v[124:127], a[60:63], v[104:107], v[124:127]
    s_nop 5
    v_cndmask_b32 v112, v112, v116, s[22:23]
    v_cndmask_b32 v113, v113, v117, s[22:23]
    v_cndmask_b32 v114, v114, v118, s[22:23]
    v_cndmask_b32 v115, v115, v119, s[22:23]
    v_cndmask_b32 v120, v120, v124, s[22:23]
    v_cndmask_b32 v121, v121, v125, s[22:23]
    v_cndmask_b32 v122, v122, v126, s[22:23]
    v_cndmask_b32 v123, v123, v127, s[22:23]
    v_cndmask_b32 v112, v112, v120, s[58:59]
    v_cndmask_b32 v113, v113, v121, s[58:59]
    v_cndmask_b32 v114, v114, v122, s[58:59]
    v_cndmask_b32 v115, v115, v123, s[58:59]
    v_mul_f32 v112, s51, v112
    v_mul_f32 v113, s51, v113
    v_mul_f32 v114, s51, v114
    v_mul_f32 v115, s51, v115
    v_perm_b32 v112, v113, v112, v252
    v_perm_b32 v113, v115, v114, v252
    v_bitop3_b32 v116, v112, v90, v255 bitop3:0x28
    v_bitop3_b32 v117, v113, v91, v255 bitop3:0x28
    v_add_u32 v112, v112, v116
    v_add_u32 v113, v113, v117
    buffer_store_dwordx2 v[112:113], v88, s[16:19], s50 offen sc1
Lsk_8:
    s_getreg_b32 s3, hwreg(HW_REG_XCC_ID, 0, 4)
    s_add_u32 s3, s3, s100
    v_mov_b32 v10, s3
    s_lshr_b32 s3, s2, 3
    s_lshl_b32 s3, s3, 2
    s_lshl_b32 s4, s9, 7
    s_add_u32 s3, s3, s4
    s_add_u32 s3, s3, 3653632
    v_cmp_eq_u32 vcc, 0, v0
    s_nop 1
    v_cndmask_b32 v7, v251, v0, vcc
    buffer_store_dword v10, v7, s[16:19], s3 offen sc1
    s_cmp_lt_u32 s11, 12
    s_cbranch_scc0 L_ga_po
    s_lshr_b32 s13, s11, 2
    s_mul_i32 s48, s8, 1327104
    s_mul_i32 s3, s9, 1152
    s_add_u32 s48, s48, s3
    s_mul_i32 s14, s13, 384
    s_add_u32 s48, s48, s14
    s_and_b32 s15, s6, 1
    s_mul_i32 s3, s15, 73728
    s_add_u32 s50, s48, s3
    s_add_u32 s50, s50, 1179648
    s_mul_i32 s3, s6, 73728
    s_add_u32 s48, s48, s3
    s_mul_i32 s49, s6, 3072
    s_add_u32 s49, s49, 8192
    s_movk_i32 s3, 2731
    s_movk_i32 s4, 8832
    v_add_u32 v7, 0, v1
    v_mul_u32_u24 v8, s3, v7
    v_lshrrev_b32 v8, 16, v8
    v_lshrrev_b32 v10, 1, v8
    v_lshlrev_b32 v10, 5, v10
    v_xor_b32 v10, v10, v6
    v_mad_u32_u24 v150, v8, s4, v10
    v_add_u32 v7, 64, v1
    v_mul_u32_u24 v8, s3, v7
    v_lshrrev_b32 v8, 16, v8
    v_lshrrev_b32 v10, 1, v8
    v_lshlrev_b32 v10, 5, v10
    v_xor_b32 v10, v10, v6
    v_mad_u32_u24 v151, v8, s4, v10
    v_add_u32 v7, 128, v1
    v_mul_u32_u24 v8, s3, v7
    v_lshrrev_b32 v8, 16, v8
    v_lshrrev_b32 v10, 1, v8
    v_lshlrev_b32 v10, 5, v10
    v_xor_b32 v10, v10, v6
    v_mad_u32_u24 v152, v8, s4, v10
    s_add_u32 m0, s49, 0
    s_nop 0
    buffer_load_dwordx4 v150, s[28:31], s48 offen offset:0 nt lds
    buffer_load_dwordx4 v151, s[28:31], s48 offen offset:1024 nt lds
    buffer_load_dwordx4 v152, s[28:31], s48 offen offset:2048 nt lds
    s_add_u32 m0, s49, 12288
    s_nop 0
    buffer_load_dwordx4 v150, s[36:39], s48 offen offset:0 nt lds
    s_barrier
    s_mul_i32 s3, s8, 288
    v_add_u32 v7, s3, v81
    ds_read2_b64 v[160:163], v7 offset0:0 offset1:4
    ds_read2_b64 v[164:167], v7 offset0:8 offset1:12
    ds_read2_b64 v[168:171], v7 offset0:16 offset1:20
    ds_read2_b64 v[172:175], v7 offset0:24 offset1:28
    ds_read_b64 v[176:177], v7 offset:256
    v_lshrrev_b32 v7, 1, v250
    v_xor_b32 v7, s6, v7
    v_lshl_add_u32 v7, v7, 5, v5
    v_lshl_add_u32 v8, v3, 2, v4
    v_mul_u32_u24 v8, 384, v8
    v_add_u32 v7, v7, v8
    v_add_u32 v156, 8192, v7
    s_movk_i32 s3, 2731
    s_movk_i32 s4, 768
    v_add_u32 v7, 0, v1
    v_mul_u32_u24 v8, s3, v7
    v_lshrrev_b32 v8, 16, v8
    v_lshrrev_b32 v10, 1, v8
    v_lshlrev_b32 v10, 5, v10
    v_xor_b32 v10, v10, v6
    v_mad_u32_u24 v153, v8, s4, v10
    v_add_u32 v7, 64, v1
    v_mul_u32_u24 v8, s3, v7
    v_lshrrev_b32 v8, 16, v8
    v_lshrrev_b32 v10, 1, v8
    v_lshlrev_b32 v10, 5, v10
    v_xor_b32 v10, v10, v6
    v_mad_u32_u24 v154, v8, s4, v10
    v_add_u32 v7, 128, v1
    v_mul_u32_u24 v8, s3, v7
    v_lshrrev_b32 v8, 16, v8
    v_lshrrev_b32 v10, 1, v8
    v_lshlrev_b32 v10, 5, v10
    v_xor_b32 v10, v10, v6
    v_mad_u32_u24 v155, v8, s4, v10
    v_lshrrev_b32 v7, 1, v2
    v_mul_u32_u24 v7, 512, v7
    v_and_b32 v8, 1, v2
    v_lshl_add_u32 v7, v8, 6, v7
    v_lshl_add_u32 v7, v3, 4, v7
    v_cmp_gt_u32 vcc, 6, v2
    s_nop 1
    v_cndmask_b32 v157, v251, v7, vcc
    v_lshrrev_b32 v7, 1, v2
    v_mul_u32_u24 v7, 16384, v7
    v_and_b32 v8, 1, v2
    v_lshl_add_u32 v7, v8, 6, v7
    v_lshl_add_u32 v7, v3, 4, v7
    v_cmp_gt_u32 vcc, 6, v2
    s_nop 1
    v_cndmask_b32 v179, v251, v7, vcc
    v_mov_b32 v111, v156
    s_cmp_lt_u32 s6, 2
    s_cselect_b64 s[40:41], s[28:29], s[36:37]
    s_mov_b32 s42, 5308416
    s_lshl_b32 s56, s9, 2
    s_add_u32 s56, s56, s8
    s_mul_i32 s51, s56, 165888
    s_add_u32 s51, s51, s14
    s_mul_i32 s3, s15, 9216
    s_add_u32 s21, s51, s3
    s_add_u32 s21, s21, 147456
    s_mul_i32 s3, s6, 9216
    s_add_u32 s51, s51, s3
    s_mul_i32 s57, s15, 3072
    s_add_u32 s57, s57, 8192
    s_mul_i32 s52, s56, 9216
    s_mul_i32 s3, s13, 1536
    s_add_u32 s52, s52, s3
    s_lshl_b32 s3, s6, 7
    s_add_u32 s52, s52, s3
    s_add_u32 s52, s52, 2490368
    s_add_u32 s53, s52, 4608
    s_add_u32 s54, s52, 720896
    s_add_u32 s55, s53, 720896
    s_lshl_b32 s56, s56, 7
    s_mul_i32 s3, s13, 49152
    s_add_u32 s56, s56, s3
    s_lshl_b32 s3, s6, 12
    s_add_u32 s56, s56, s3
    s_add_u32 s56, s56, 3833856
    v_lshrrev_b32 v7, 3, v1
    v_lshl_add_u32 v7, v7, 2, s6
    v_mov_b32 v8, s6
    v_cmp_gt_u32 vcc, 9, v7
    s_nop 1
    v_cndmask_b32 v7, v8, v7, vcc
    v_and_b32 v8, 7, v1
    v_lshlrev_b32 v8, 4, v8
    v_lshl_add_u32 v158, v7, 7, v8
    v_bfe_u32 v8, v1, 2, 1
    v_mul_u32_u24 v8, 320, v8
    v_lshl_add_u32 v8, v7, 5, v8
    v_add_u32 v8, v8, v5
    v_add_u32 v159, 2560, v8
    v_and_b32 v7, 1, v2
    v_mul_u32_u24 v7, 320, v7
    v_lshl_add_u32 v7, v3, 3, v7
    v_add_u32 v178, 2560, v7
    s_mul_i32 s68, s9, 36864
    s_mul_i32 s3, s8, 1152
    s_add_u32 s68, s68, s3
    s_add_u32 s68, s68, 2490368
    v_mov_b32 v232, 0xbdd2d3e8
    v_mov_b32 v233, 0xbdd2d3e8
    v_mov_b32 v234, 0xc0135761
    v_mov_b32 v235, 0xc0135761
    s_add_u32 s69, s68, 4608
    s_add_u32 s70, s68, 9216
    s_add_u32 s71, s68, 13824
    s_add_u32 s72, s68, 18432
    s_add_u32 s73, s68, 23040
    s_add_u32 s74, s68, 27648
    s_add_u32 s75, s68, 32256
    s_waitcnt vmcnt(3)
    buffer_load_dwordx4 v151, s[36:39], s48 offen offset:1024 nt lds
    s_waitcnt vmcnt(3)
    buffer_load_dwordx4 v152, s[36:39], s48 offen offset:2048 nt lds
    s_waitcnt vmcnt(3)
    s_add_u32 m0, s49, 24576
    s_add_u32 s48, s48, 294912
    buffer_load_dwordx4 v150, s[28:31], s48 offen offset:0 nt lds
    s_waitcnt vmcnt(3)
    buffer_load_dwordx4 v151, s[28:31], s48 offen offset:1024 nt lds
    buffer_load_dwordx4 v152, s[28:31], s48 offen offset:2048 nt lds
    s_add_u32 m0, s49, 36864
    s_nop 0
    buffer_load_dwordx4 v150, s[36:39], s48 offen offset:0 nt lds
    buffer_load_dwordx4 v151, s[36:39], s48 offen offset:1024 nt lds
    buffer_load_dwordx4 v152, s[36:39], s48 offen offset:2048 nt lds
    s_waitcnt vmcnt(11)
    s_add_u32 m0, s49, 49152
    s_add_u32 s48, s48, 294912
    buffer_load_dwordx4 v150, s[28:31], s48 offen offset:0 nt lds
    s_waitcnt vmcnt(11)
    buffer_load_dwordx4 v151, s[28:31], s48 offen offset:1024 nt lds
    s_waitcnt vmcnt(11)
    buffer_load_dwordx4 v152, s[28:31], s48 offen offset:2048 nt lds
    s_waitcnt vmcnt(11)
    s_add_u32 m0, s49, 61440
    s_nop 0
    buffer_load_dwordx4 v150, s[36:39], s48 offen offset:0 nt lds
    s_waitcnt vmcnt(11)
    buffer_load_dwordx4 v151, s[36:39], s48 offen offset:1024 nt lds
    s_waitcnt vmcnt(11)
    buffer_load_dwordx4 v152, s[36:39], s48 offen offset:2048 nt lds
    s_waitcnt vmcnt(12)
    s_barrier
    ds_read_b64_tr_b16 v[204:205], v156 offset:0
    ds_read_b64_tr_b16 v[206:207], v156 offset:6144
    ds_read_b64_tr_b16 v[208:209], v156 offset:128
    ds_read_b64_tr_b16 v[210:211], v156 offset:6272
    ds_read_b64_tr_b16 v[212:213], v156 offset:256
    ds_read_b64_tr_b16 v[214:215], v156 offset:6400
    ds_read_b64_tr_b16 v[216:217], v156 offset:12288
    ds_read_b64_tr_b16 v[218:219], v156 offset:18432
    ds_read_b64_tr_b16 v[220:221], v156 offset:12416
    ds_read_b64_tr_b16 v[222:223], v156 offset:18560
    ds_read_b64_tr_b16 v[224:225], v156 offset:12544
    ds_read_b64_tr_b16 v[226:227], v156 offset:18688
    s_waitcnt vmcnt(11)
    s_add_u32 m0, s49, 73728
    s_add_u32 s48, s48, 294912
    buffer_load_dwordx4 v150, s[28:31], s48 offen offset:0 nt lds
    s_waitcnt vmcnt(11)
    buffer_load_dwordx4 v151, s[28:31], s48 offen offset:1024 nt lds
    s_waitcnt lgkmcnt(10)
    v_mfma_f32_16x16x32_bf16 v[180:183], v[204:207], v[160:163], 0
    s_waitcnt lgkmcnt(8)
    v_mfma_f32_16x16x32_bf16 v[184:187], v[208:211], v[160:163], 0
    s_waitcnt lgkmcnt(6)
    v_mfma_f32_16x16x32_bf16 v[188:191], v[212:215], v[160:163], 0
    s_waitcnt lgkmcnt(4)
    v_mfma_f32_16x16x32_bf16 v[192:195], v[216:219], v[160:163], 0
    s_waitcnt lgkmcnt(2)
    v_mfma_f32_16x16x32_bf16 v[196:199], v[220:223], v[160:163], 0
    s_waitcnt lgkmcnt(0)
    v_mfma_f32_16x16x32_bf16 v[200:203], v[224:227], v[160:163], 0
    buffer_load_dword v9, v158, s[16:19], s68 offen sc1
    buffer_load_dword v9, v158, s[16:19], s69 offen sc1
    buffer_load_dword v9, v158, s[16:19], s70 offen sc1
    buffer_load_dword v9, v158, s[16:19], s71 offen sc1
    buffer_load_dword v9, v158, s[16:19], s72 offen sc1
    buffer_load_dword v9, v158, s[16:19], s73 offen sc1
    buffer_load_dword v9, v158, s[16:19], s74 offen sc1
    buffer_load_dword v9, v158, s[16:19], s75 offen sc1
    v_and_b32 v7, 31, v1
    v_lshlrev_b32 v7, 2, v7
    s_lshl_b32 s3, s9, 7
    s_add_u32 s3, s3, 3653632
    buffer_load_dword v110, v7, s[16:19], s3 offen sc1
    s_waitcnt vmcnt(20)
    buffer_load_dwordx4 v152, s[28:31], s48 offen offset:2048 nt lds
    s_waitcnt vmcnt(20)
    s_add_u32 m0, s49, 86016
    s_nop 0
    buffer_load_dwordx4 v150, s[36:39], s48 offen offset:0 nt lds
    s_waitcnt vmcnt(20)
    buffer_load_dwordx4 v151, s[36:39], s48 offen offset:1024 nt lds
    s_waitcnt vmcnt(20)
    buffer_load_dwordx4 v152, s[36:39], s48 offen offset:2048 nt lds
    s_waitcnt vmcnt(21)
    s_barrier
    ds_read_b64_tr_b16 v[204:205], v156 offset:24576
    ds_read_b64_tr_b16 v[206:207], v156 offset:30720
    ds_read_b64_tr_b16 v[208:209], v156 offset:24704
    ds_read_b64_tr_b16 v[210:211], v156 offset:30848
    ds_read_b64_tr_b16 v[212:213], v156 offset:24832
    ds_read_b64_tr_b16 v[214:215], v156 offset:30976
    ds_read_b64_tr_b16 v[216:217], v156 offset:36864
    ds_read_b64_tr_b16 v[218:219], v156 offset:43008
    ds_read_b64_tr_b16 v[220:221], v156 offset:36992
    ds_read_b64_tr_b16 v[222:223], v156 offset:43136
    ds_read_b64_tr_b16 v[224:225], v156 offset:37120
    ds_read_b64_tr_b16 v[226:227], v156 offset:43264
    v_add_u32 v156, 49152, v156
    s_waitcnt vmcnt(20)
    s_add_u32 m0, s49, 98304
    s_nop 0
    buffer_load_dwordx4 v150, s[40:43], s50 offen offset:0 nt lds
    s_waitcnt vmcnt(20)
    buffer_load_dwordx4 v151, s[40:43], s50 offen offset:1024 nt lds
    s_waitcnt lgkmcnt(10)
    v_mfma_f32_16x16x32_bf16 v[180:183], v[204:207], v[164:167], v[180:183]
    s_waitcnt lgkmcnt(8)
    v_mfma_f32_16x16x32_bf16 v[184:187], v[208:211], v[164:167], v[184:187]
    s_waitcnt lgkmcnt(6)
    v_mfma_f32_16x16x32_bf16 v[188:191], v[212:215], v[164:167], v[188:191]
    s_waitcnt vmcnt(20)
    buffer_load_dwordx4 v152, s[40:43], s50 offen offset:2048 nt lds
    s_waitcnt lgkmcnt(4)
    v_mfma_f32_16x16x32_bf16 v[192:195], v[216:219], v[164:167], v[192:195]
    s_waitcnt lgkmcnt(2)
    v_mfma_f32_16x16x32_bf16 v[196:199], v[220:223], v[164:167], v[196:199]
    s_waitcnt lgkmcnt(0)
    v_mfma_f32_16x16x32_bf16 v[200:203], v[224:227], v[164:167], v[200:203]
    s_waitcnt vmcnt(20)
    s_add_u32 m0, s49, 110592
    s_nop 0
    buffer_load_dwordx4 v153, s[32:35], s51 offen offset:0 nt lds
    s_waitcnt vmcnt(20)
    buffer_load_dwordx4 v154, s[32:35], s51 offen offset:1024 nt lds
    s_waitcnt vmcnt(20)
    buffer_load_dwordx4 v155, s[32:35], s51 offen offset:2048 nt lds
    s_waitcnt vmcnt(21)
    s_barrier
    ds_read_b64_tr_b16 v[204:205], v156 offset:0
    ds_read_b64_tr_b16 v[206:207], v156 offset:6144
    ds_read_b64_tr_b16 v[208:209], v156 offset:128
    ds_read_b64_tr_b16 v[210:211], v156 offset:6272
    ds_read_b64_tr_b16 v[212:213], v156 offset:256
    ds_read_b64_tr_b16 v[214:215], v156 offset:6400
    ds_read_b64_tr_b16 v[216:217], v156 offset:12288
    ds_read_b64_tr_b16 v[218:219], v156 offset:18432
    ds_read_b64_tr_b16 v[220:221], v156 offset:12416
    ds_read_b64_tr_b16 v[222:223], v156 offset:18560
    ds_read_b64_tr_b16 v[224:225], v156 offset:12544
    ds_read_b64_tr_b16 v[226:227], v156 offset:18688
    s_waitcnt vmcnt(20)
    s_add_u32 m0, s49, 122880
    s_add_u32 s51, s51, 36864
    buffer_load_dwordx4 v153, s[32:35], s51 offen offset:0 nt lds
    s_waitcnt vmcnt(20)
    buffer_load_dwordx4 v154, s[32:35], s51 offen offset:1024 nt lds
    s_waitcnt lgkmcnt(10)
    v_mfma_f32_16x16x32_bf16 v[180:183], v[204:207], v[168:171], v[180:183]
    s_waitcnt lgkmcnt(8)
    v_mfma_f32_16x16x32_bf16 v[184:187], v[208:211], v[168:171], v[184:187]
    s_waitcnt lgkmcnt(6)
    v_mfma_f32_16x16x32_bf16 v[188:191], v[212:215], v[168:171], v[188:191]
    s_waitcnt vmcnt(11)
    buffer_load_dwordx4 v155, s[32:35], s51 offen offset:2048 nt lds
    s_waitcnt lgkmcnt(4)
    v_mfma_f32_16x16x32_bf16 v[192:195], v[216:219], v[168:171], v[192:195]
    s_waitcnt lgkmcnt(2)
    v_mfma_f32_16x16x32_bf16 v[196:199], v[220:223], v[168:171], v[196:199]
    s_waitcnt lgkmcnt(0)
    v_mfma_f32_16x16x32_bf16 v[200:203], v[224:227], v[168:171], v[200:203]
    s_waitcnt vmcnt(11)
    s_add_u32 m0, s49, 135168
    s_add_u32 s51, s51, 36864
    buffer_load_dwordx4 v153, s[32:35], s51 offen offset:0 nt lds
    s_waitcnt vmcnt(11)
    buffer_load_dwordx4 v154, s[32:35], s51 offen offset:1024 nt lds
    s_waitcnt vmcnt(11)
    buffer_load_dwordx4 v155, s[32:35], s51 offen offset:2048 nt lds
    s_waitcnt vmcnt(12)
    s_barrier
    ds_read_b64_tr_b16 v[204:205], v156 offset:24576
    ds_read_b64_tr_b16 v[206:207], v156 offset:30720
    ds_read_b64_tr_b16 v[208:209], v156 offset:24704
    ds_read_b64_tr_b16 v[210:211], v156 offset:30848
    ds_read_b64_tr_b16 v[212:213], v156 offset:24832
    ds_read_b64_tr_b16 v[214:215], v156 offset:30976
    ds_read_b64_tr_b16 v[216:217], v156 offset:36864
    ds_read_b64_tr_b16 v[218:219], v156 offset:43008
    ds_read_b64_tr_b16 v[220:221], v156 offset:36992
    ds_read_b64_tr_b16 v[222:223], v156 offset:43136
    ds_read_b64_tr_b16 v[224:225], v156 offset:37120
    ds_read_b64_tr_b16 v[226:227], v156 offset:43264
    v_add_u32 v156, 49152, v156
    s_waitcnt vmcnt(11)
    s_add_u32 m0, s49, 0
    s_add_u32 s51, s51, 36864
    buffer_load_dwordx4 v153, s[32:35], s51 offen offset:0 nt lds
    s_waitcnt vmcnt(11)
    buffer_load_dwordx4 v154, s[32:35], s51 offen offset:1024 nt lds
    s_waitcnt lgkmcnt(10)
    v_mfma_f32_16x16x32_bf16 v[180:183], v[204:207], v[172:175], v[180:183]
    s_waitcnt lgkmcnt(8)
    v_mfma_f32_16x16x32_bf16 v[184:187], v[208:211], v[172:175], v[184:187]
    s_waitcnt lgkmcnt(6)
    v_mfma_f32_16x16x32_bf16 v[188:191], v[212:215], v[172:175], v[188:191]
    s_waitcnt vmcnt(11)
    buffer_load_dwordx4 v155, s[32:35], s51 offen offset:2048 nt lds
    s_waitcnt lgkmcnt(4)
    v_mfma_f32_16x16x32_bf16 v[192:195], v[216:219], v[172:175], v[192:195]
    s_waitcnt lgkmcnt(2)
    v_mfma_f32_16x16x32_bf16 v[196:199], v[220:223], v[172:175], v[196:199]
    s_waitcnt lgkmcnt(0)
    v_mfma_f32_16x16x32_bf16 v[200:203], v[224:227], v[172:175], v[200:203]
    s_waitcnt vmcnt(12)
    s_barrier
    ds_read_b64_tr_b16 v[204:205], v156 offset:0
    ds_read_b64_tr_b16 v[208:209], v156 offset:128
    ds_read_b64_tr_b16 v[212:213], v156 offset:256
    ds_read_b64_tr_b16 v[216:217], v156 offset:6144
    ds_read_b64_tr_b16 v[220:221], v156 offset:6272
    ds_read_b64_tr_b16 v[224:225], v156 offset:6400
    s_waitcnt lgkmcnt(5)
    v_mfma_f32_16x16x16_bf16 v[180:183], v[204:205], v[176:177], v[180:183]
    s_waitcnt lgkmcnt(4)
    v_mfma_f32_16x16x16_bf16 v[184:187], v[208:209], v[176:177], v[184:187]
    s_waitcnt lgkmcnt(3)
    v_mfma_f32_16x16x16_bf16 v[188:191], v[212:213], v[176:177], v[188:191]
    s_waitcnt lgkmcnt(2)
    v_mfma_f32_16x16x16_bf16 v[192:195], v[216:217], v[176:177], v[192:195]
    s_waitcnt lgkmcnt(1)
    v_mfma_f32_16x16x16_bf16 v[196:199], v[220:221], v[176:177], v[196:199]
    s_waitcnt lgkmcnt(0)
    v_mfma_f32_16x16x16_bf16 v[200:203], v[224:225], v[176:177], v[200:203]
    v_cndmask_b32 v180, v180, v184, s[22:23]
    v_cndmask_b32 v181, v181, v185, s[22:23]
    v_cndmask_b32 v182, v182, v186, s[22:23]
    v_cndmask_b32 v183, v183, v187, s[22:23]
    v_cndmask_b32 v180, v180, v188, s[58:59]
    v_cndmask_b32 v181, v181, v189, s[58:59]
    v_cndmask_b32 v182, v182, v190, s[58:59]
    v_cndmask_b32 v183, v183, v191, s[58:59]
    v_and_or_b32 v180, v180, v254, v236
    v_and_or_b32 v181, v181, v254, v237
    v_and_or_b32 v182, v182, v254, v238
    v_and_or_b32 v183, v183, v254, v239
    buffer_store_dwordx4 v[180:183], v157, s[16:19], s52 offen
    v_cndmask_b32 v192, v192, v196, s[22:23]
    v_cndmask_b32 v193, v193, v197, s[22:23]
    v_cndmask_b32 v194, v194, v198, s[22:23]
    v_cndmask_b32 v195, v195, v199, s[22:23]
    v_cndmask_b32 v192, v192, v200, s[58:59]
    v_cndmask_b32 v193, v193, v201, s[58:59]
    v_cndmask_b32 v194, v194, v202, s[58:59]
    v_cndmask_b32 v195, v195, v203, s[58:59]
    v_and_or_b32 v192, v192, v254, v236
    v_and_or_b32 v193, v193, v254, v237
    v_and_or_b32 v194, v194, v254, v238
    v_and_or_b32 v195, v195, v254, v239
    buffer_store_dwordx4 v[192:195], v157, s[16:19], s53 offen
    s_getreg_b32 s3, hwreg(HW_REG_XCC_ID, 0, 4)
    s_add_u32 s3, s3, s100
    v_cmp_ne_u32 vcc, s3, v110
    s_cbranch_vccz Lx_9
    buffer_store_dwordx4 v[180:183], v157, s[16:19], s54 offen sc1
    buffer_store_dwordx4 v[192:195], v157, s[16:19], s55 offen sc1
Lx_9:
    s_waitcnt vmcnt(13)
    s_add_u32 m0, s57, 12288
    s_nop 0
    buffer_load_dwordx4 v153, s[32:35], s21 offen offset:0 nt lds
    s_waitcnt vmcnt(13)
    buffer_load_dwordx4 v154, s[32:35], s21 offen offset:1024 nt lds
    s_waitcnt vmcnt(13)
    buffer_load_dwordx4 v155, s[32:35], s21 offen offset:2048 nt lds
    s_waitcnt vmcnt(8)
    s_barrier
    ds_read_b64_tr_b16 a[0:1], v156 offset:12288
    ds_read_b64_tr_b16 a[2:3], v156 offset:18432
    ds_read_b64_tr_b16 a[4:5], v156 offset:12416
    ds_read_b64_tr_b16 a[6:7], v156 offset:18560
    ds_read_b64_tr_b16 a[8:9], v156 offset:12544
    ds_read_b64_tr_b16 a[10:11], v156 offset:18688
    ds_read_b64_tr_b16 a[12:13], v156 offset:24576
    ds_read_b64_tr_b16 a[14:15], v156 offset:30720
    ds_read_b64_tr_b16 a[16:17], v156 offset:24704
    ds_read_b64_tr_b16 a[18:19], v156 offset:30848
    ds_read_b64_tr_b16 a[20:21], v156 offset:24832
    ds_read_b64_tr_b16 a[22:23], v156 offset:30976
    ds_read_b64_tr_b16 a[24:25], v156 offset:36864
    ds_read_b64_tr_b16 a[26:27], v156 offset:43008
    ds_read_b64_tr_b16 a[28:29], v156 offset:36992
    ds_read_b64_tr_b16 a[30:31], v156 offset:43136
    ds_read_b64_tr_b16 a[32:33], v156 offset:37120
    ds_read_b64_tr_b16 a[34:35], v156 offset:43264
    s_waitcnt vmcnt(5)
    buffer_load_dwordx4 v[24:27], v158, s[16:19], s68 offen sc1
    buffer_load_dwordx4 v[28:31], v158, s[16:19], s69 offen sc1
    buffer_load_dwordx4 v[32:35], v158, s[16:19], s70 offen sc1
    buffer_load_dwordx4 v[36:39], v158, s[16:19], s71 offen sc1
    buffer_load_dwordx4 v[40:43], v158, s[16:19], s72 offen sc1
    buffer_load_dwordx4 v[44:47], v158, s[16:19], s73 offen sc1
    buffer_load_dwordx4 v[48:51], v158, s[16:19], s74 offen sc1
    buffer_load_dwordx4 v[52:55], v158, s[16:19], s75 offen sc1
    s_mov_b32 s60, 60000
    s_waitcnt vmcnt(0)
Lp_10:
    v_xor_b32 v7, v236, v24
    v_bitop3_b32 v7, v7, v25, v237 bitop3:0xf6
    v_bitop3_b32 v7, v7, v26, v238 bitop3:0xf6
    v_bitop3_b32 v7, v7, v27, v239 bitop3:0xf6
    v_bitop3_b32 v7, v7, v28, v236 bitop3:0xf6
    v_bitop3_b32 v7, v7, v29, v237 bitop3:0xf6
    v_bitop3_b32 v7, v7, v30, v238 bitop3:0xf6
    v_bitop3_b32 v7, v7, v31, v239 bitop3:0xf6
    v_bitop3_b32 v7, v7, v32, v236 bitop3:0xf6
    v_bitop3_b32 v7, v7, v33, v237 bitop3:0xf6
    v_bitop3_b32 v7, v7, v34, v238 bitop3:0xf6
    v_bitop3_b32 v7, v7, v35, v239 bitop3:0xf6
    v_bitop3_b32 v7, v7, v36, v236 bitop3:0xf6
    v_bitop3_b32 v7, v7, v37, v237 bitop3:0xf6
    v_bitop3_b32 v7, v7, v38, v238 bitop3:0xf6
    v_bitop3_b32 v7, v7, v39, v239 bitop3:0xf6
    v_bitop3_b32 v7, v7, v40, v236 bitop3:0xf6
    v_bitop3_b32 v7, v7, v41, v237 bitop3:0xf6
    v_bitop3_b32 v7, v7, v42, v238 bitop3:0xf6
    v_bitop3_b32 v7, v7, v43, v239 bitop3:0xf6
    v_bitop3_b32 v7, v7, v44, v236 bitop3:0xf6
    v_bitop3_b32 v7, v7, v45, v237 bitop3:0xf6
    v_bitop3_b32 v7, v7, v46, v238 bitop3:0xf6
    v_bitop3_b32 v7, v7, v47, v239 bitop3:0xf6
    v_bitop3_b32 v7, v7, v48, v236 bitop3:0xf6
    v_bitop3_b32 v7, v7, v49, v237 bitop3:0xf6
    v_bitop3_b32 v7, v7, v50, v238 bitop3:0xf6
    v_bitop3_b32 v7, v7, v51, v239 bitop3:0xf6
    v_bitop3_b32 v7, v7, v52, v236 bitop3:0xf6
    v_bitop3_b32 v7, v7, v53, v237 bitop3:0xf6
    v_bitop3_b32 v7, v7, v54, v238 bitop3:0xf6
    v_bitop3_b32 v7, v7, v55, v239 bitop3:0xf6
    v_and_b32 v7, 0xff, v7
    v_cmp_ne_u32 vcc, 0, v7
    s_cbranch_vccz Lok_11
    s_sub_u32 s60, s60, 1
    s_cbranch_scc1 Lok_11
    s_cmp_le_u32 s60, 59976
    s_cselect_b32 s3, s60, 1
    s_and_b32 s3, s3, 7
    s_cselect_b32 s3, 0, 720896
    v_add_u32 v8, s3, v158
    buffer_load_dwordx4 v[24:27], v8, s[16:19], s68 offen sc1
    buffer_load_dwordx4 v[28:31], v8, s[16:19], s69 offen sc1
    buffer_load_dwordx4 v[32:35], v8, s[16:19], s70 offen sc1
    buffer_load_dwordx4 v[36:39], v8, s[16:19], s71 offen sc1
    buffer_load_dwordx4 v[40:43], v8, s[16:19], s72 offen sc1
    buffer_load_dwordx4 v[44:47], v8, s[16:19], s73 offen sc1
    buffer_load_dwordx4 v[48:51], v8, s[16:19], s74 offen sc1
    buffer_load_dwordx4 v[52:55], v8, s[16:19], s75 offen sc1
    s_waitcnt vmcnt(0)
    s_branch Lp_10
Lok_11:
    v_pk_add_f32 v[24:25], v[24:25], v[32:33]
    v_pk_add_f32 v[40:41], v[40:41], v[48:49]
    v_pk_add_f32 v[26:27], v[26:27], v[34:35]
    v_pk_add_f32 v[42:43], v[42:43], v[50:51]
    v_pk_add_f32 v[28:29], v[28:29], v[36:37]
    v_pk_add_f32 v[44:45], v[44:45], v[52:53]
    v_pk_add_f32 v[30:31], v[30:31], v[38:39]
    v_pk_add_f32 v[46:47], v[46:47], v[54:55]
    v_pk_add_f32 v[24:25], v[24:25], v[40:41]
    v_pk_add_f32 v[26:27], v[26:27], v[42:43]
    v_pk_add_f32 v[28:29], v[28:29], v[44:45]
    v_pk_add_f32 v[30:31], v[30:31], v[46:47]
    v_cvt_pk_bf16_f32 v32, v24, v25
    v_cvt_pk_bf16_f32 v33, v26, v27
    v_cvt_pk_bf16_f32 v34, v28, v29
    v_cvt_pk_bf16_f32 v35, v30, v31
    v_lshlrev_b32 v24, 16, v32
    v_and_b32 v25, 0xffff0000, v32
    v_lshlrev_b32 v26, 16, v33
    v_and_b32 v27, 0xffff0000, v33
    v_lshlrev_b32 v28, 16, v34
    v_and_b32 v29, 0xffff0000, v34
    v_lshlrev_b32 v30, 16, v35
    v_and_b32 v31, 0xffff0000, v35
    v_pk_mul_f32 v[32:33], v[24:25], v[24:25]
    v_pk_mul_f32 v[34:35], v[26:27], v[26:27]
    v_pk_fma_f32 v[32:33], v[32:33], v[232:233], v[234:235]
    v_pk_fma_f32 v[34:35], v[34:35], v[232:233], v[234:235]
    v_pk_mul_f32 v[32:33], v[32:33], v[24:25]
    v_pk_mul_f32 v[34:35], v[34:35], v[26:27]
    v_exp_f32 v32, v32
    v_exp_f32 v33, v33
    v_exp_f32 v34, v34
    v_exp_f32 v35, v35
    v_add_f32 v32, 1.0, v32
    v_add_f32 v33, 1.0, v33
    v_add_f32 v34, 1.0, v34
    v_add_f32 v35, 1.0, v35
    v_rcp_f32 v32, v32
    v_rcp_f32 v33, v33
    v_rcp_f32 v34, v34
    v_rcp_f32 v35, v35
    v_pk_mul_f32 v[32:33], v[32:33], v[24:25]
    v_pk_mul_f32 v[34:35], v[34:35], v[26:27]
    v_cvt_pk_bf16_f32 v36, v32, v33
    v_cvt_pk_bf16_f32 v37, v34, v35
    v_lshlrev_b32 v32, 16, v36
    v_and_b32 v33, 0xffff0000, v36
    v_lshlrev_b32 v34, 16, v37
    v_and_b32 v35, 0xffff0000, v37
    v_pk_mul_f32 v[32:33], v[32:33], v[28:29]
    v_pk_mul_f32 v[34:35], v[34:35], v[30:31]
    v_cvt_pk_bf16_f32 v36, v32, v33
    v_cvt_pk_bf16_f32 v37, v34, v35
    ds_write_b64 v159, v[36:37]
    s_waitcnt lgkmcnt(0)
    s_barrier
    ds_read2_b64 v[56:59], v178 offset0:0 offset1:4
    ds_read2_b64 v[60:63], v178 offset0:8 offset1:12
    ds_read2_b64 v[64:67], v178 offset0:16 offset1:20
    ds_read_b64_tr_b16 a[36:37], v111 offset:0
    ds_read_b64_tr_b16 a[38:39], v111 offset:6144
    ds_read_b64_tr_b16 a[40:41], v111 offset:128
    ds_read_b64_tr_b16 a[42:43], v111 offset:6272
    ds_read_b64_tr_b16 a[44:45], v111 offset:256
    ds_read_b64_tr_b16 a[46:47], v111 offset:6400
    ds_read2_b64 v[68:71], v178 offset0:24 offset1:28
    ds_read_b64_tr_b16 a[48:49], v111 offset:12288
    ds_read_b64_tr_b16 a[52:53], v111 offset:12416
    ds_read_b64_tr_b16 a[56:57], v111 offset:12544
    ds_read_b64 v[72:73], v178 offset:256
    s_waitcnt lgkmcnt(13)
    v_mfma_f32_16x16x32_bf16 v[204:207], a[0:3], v[56:59], 0
    v_mfma_f32_16x16x32_bf16 v[208:211], a[4:7], v[56:59], 0
    v_mfma_f32_16x16x32_bf16 v[212:215], a[8:11], v[56:59], 0
    s_waitcnt lgkmcnt(12)
    v_mfma_f32_16x16x32_bf16 v[204:207], a[12:15], v[60:63], v[204:207]
    v_mfma_f32_16x16x32_bf16 v[208:211], a[16:19], v[60:63], v[208:211]
    v_mfma_f32_16x16x32_bf16 v[212:215], a[20:23], v[60:63], v[212:215]
    s_waitcnt lgkmcnt(11)
    v_mfma_f32_16x16x32_bf16 v[204:207], a[24:27], v[64:67], v[204:207]
    v_mfma_f32_16x16x32_bf16 v[208:211], a[28:31], v[64:67], v[208:211]
    v_mfma_f32_16x16x32_bf16 v[212:215], a[32:35], v[64:67], v[212:215]
    s_waitcnt lgkmcnt(4)
    v_mfma_f32_16x16x32_bf16 v[204:207], a[36:39], v[68:71], v[204:207]
    v_mfma_f32_16x16x32_bf16 v[208:211], a[40:43], v[68:71], v[208:211]
    v_mfma_f32_16x16x32_bf16 v[212:215], a[44:47], v[68:71], v[212:215]
    s_waitcnt lgkmcnt(0)
    v_mfma_f32_16x16x16_bf16 v[204:207], a[48:49], v[72:73], v[204:207]
    v_mfma_f32_16x16x16_bf16 v[208:211], a[52:53], v[72:73], v[208:211]
    v_mfma_f32_16x16x16_bf16 v[212:215], a[56:57], v[72:73], v[212:215]
    s_nop 6
    v_cndmask_b32 v204, v204, v208, s[22:23]
    v_cndmask_b32 v205, v205, v209, s[22:23]
    v_cndmask_b32 v206, v206, v210, s[22:23]
    v_cndmask_b32 v207, v207, v211, s[22:23]
    v_cndmask_b32 v204, v204, v212, s[58:59]
    v_cndmask_b32 v205, v205, v213, s[58:59]
    v_cndmask_b32 v206, v206, v214, s[58:59]
    v_cndmask_b32 v207, v207, v215, s[58:59]
    v_and_or_b32 v204, v204, v254, v236
    v_and_or_b32 v205, v205, v254, v237
    v_and_or_b32 v206, v206, v254, v238
    v_and_or_b32 v207, v207, v254, v239
    buffer_store_dwordx4 v[204:207], v179, s[16:19], s56 offen sc1
    s_endpgm
L_ga_po:
    s_load_dwordx2 s[28:29], s[0:1], 40
    s_mov_b32 s30, 4718592
    s_mov_b32 s31, 0x20000
    s_lshl_b32 s13, s9, 2
    s_add_u32 s13, s13, s8
    s_mul_i32 s48, s13, 147456
    s_mul_i32 s49, s6, 9216
    s_add_u32 s48, s48, s49
    s_add_u32 s49, s49, 8192
    s_movk_i32 s3, 1821
    v_add_u32 v7, 0, v1
    v_mul_u32_u24 v8, s3, v7
    v_lshrrev_b32 v8, 18, v8
    v_lshlrev_b32 v8, 5, v8
    v_xor_b32 v8, v8, v6
    v_add_u32 v150, 0, v8
    v_add_u32 v7, 64, v1
    v_mul_u32_u24 v8, s3, v7
    v_lshrrev_b32 v8, 18, v8
    v_lshlrev_b32 v8, 5, v8
    v_xor_b32 v8, v8, v6
    v_add_u32 v151, 0, v8
    v_add_u32 v7, 128, v1
    v_mul_u32_u24 v8, s3, v7
    v_lshrrev_b32 v8, 18, v8
    v_lshlrev_b32 v8, 5, v8
    v_xor_b32 v8, v8, v6
    v_add_u32 v152, 0, v8
    v_add_u32 v7, 192, v1
    v_mul_u32_u24 v8, s3, v7
    v_lshrrev_b32 v8, 18, v8
    v_lshlrev_b32 v8, 5, v8
    v_xor_b32 v8, v8, v6
    v_add_u32 v153, 0, v8
    v_add_u32 v7, 256, v1
    v_mul_u32_u24 v8, s3, v7
    v_lshrrev_b32 v8, 18, v8
    v_lshlrev_b32 v8, 5, v8
    v_xor_b32 v8, v8, v6
    v_add_u32 v154, 4096, v8
    v_add_u32 v7, 320, v1
    v_mul_u32_u24 v8, s3, v7
    v_lshrrev_b32 v8, 18, v8
    v_lshlrev_b32 v8, 5, v8
    v_xor_b32 v8, v8, v6
    v_add_u32 v155, 4096, v8
    v_add_u32 v7, 384, v1
    v_mul_u32_u24 v8, s3, v7
    v_lshrrev_b32 v8, 18, v8
    v_lshlrev_b32 v8, 5, v8
    v_xor_b32 v8, v8, v6
    v_add_u32 v156, 4096, v8
    v_add_u32 v7, 448, v1
    v_mul_u32_u24 v8, s3, v7
    v_lshrrev_b32 v8, 18, v8
    v_lshlrev_b32 v8, 5, v8
    v_xor_b32 v8, v8, v6
    v_add_u32 v157, 4096, v8
    v_add_u32 v7, 512, v1
    v_mul_u32_u24 v8, s3, v7
    v_lshrrev_b32 v8, 18, v8
    v_lshlrev_b32 v8, 5, v8
    v_xor_b32 v8, v8, v6
    v_add_u32 v158, 8192, v8
    s_waitcnt lgkmcnt(0)
    s_barrier
    s_add_u32 m0, s49, 0
    s_nop 0
    buffer_load_dwordx4 v150, s[28:31], s48 offen offset:0 nt lds
    v_lshrrev_b32 v7, 1, v250
    v_xor_b32 v7, s6, v7
    v_lshl_add_u32 v7, v7, 5, v5
    v_lshl_add_u32 v8, v3, 2, v4
    v_mul_u32_u24 v8, 1152, v8
    v_add_u32 v7, v7, v8
    v_add_u32 v160, 8192, v7
    v_lshrrev_b32 v7, 1, v2
    v_mul_u32_u24 v7, 16384, v7
    v_and_b32 v8, 1, v2
    v_lshl_add_u32 v7, v8, 6, v7
    v_lshl_add_u32 v7, v3, 4, v7
    v_cmp_gt_u32 vcc, 6, v2
    s_nop 1
    v_cndmask_b32 v161, v251, v7, vcc
    s_lshl_b32 s3, s6, 6
    s_add_u32 s3, s3, 2560
    v_bfe_u32 v7, v2, 2, 1
    v_lshlrev_b32 v7, 8, v7
    v_lshrrev_b32 v8, 3, v2
    v_lshl_add_u32 v7, v8, 5, v7
    v_lshl_add_u32 v7, v3, 3, v7
    v_add_u32 v162, s3, v7
    v_and_b32 v7, 1, v2
    v_lshlrev_b32 v7, 8, v7
    v_lshl_add_u32 v7, v3, 3, v7
    v_add_u32 v163, 2560, v7
    s_lshl_b32 s50, s13, 12
    s_lshl_b32 s3, s6, 10
    s_add_u32 s50, s50, s3
    s_add_u32 s50, s50, 2359296
    s_lshl_b32 s52, s6, 12
    s_lshl_b32 s3, s13, 7
    s_add_u32 s52, s52, s3
    s_add_u32 s52, s52, 3670016
    s_add_u32 s53, s52, 49152
    s_add_u32 s54, s52, 98304
    buffer_load_dword v9, v6, s[16:19], s50 offen sc1
    s_waitcnt vmcnt(1)
    buffer_load_dwordx4 v151, s[28:31], s48 offen offset:1024 nt lds
    s_waitcnt vmcnt(0)
    buffer_load_dwordx4 v152, s[28:31], s48 offen offset:2048 nt lds
    buffer_load_dwordx4 v153, s[28:31], s48 offen offset:3072 nt lds
    s_add_u32 m0, s49, 4096
    s_nop 0
    buffer_load_dwordx4 v154, s[28:31], s48 offen offset:0 nt lds
    buffer_load_dwordx4 v155, s[28:31], s48 offen offset:1024 nt lds
    buffer_load_dwordx4 v156, s[28:31], s48 offen offset:2048 nt lds
    buffer_load_dwordx4 v157, s[28:31], s48 offen offset:3072 nt lds
    s_add_u32 m0, s49, 8192
    s_nop 0
    buffer_load_dwordx4 v158, s[28:31], s48 offen offset:0 nt lds
    s_add_u32 m0, s49, 36864
    s_add_u32 s48, s48, 36864
    buffer_load_dwordx4 v150, s[28:31], s48 offen offset:0 nt lds
    buffer_load_dwordx4 v151, s[28:31], s48 offen offset:1024 nt lds
    buffer_load_dwordx4 v152, s[28:31], s48 offen offset:2048 nt lds
    s_waitcnt vmcnt(12)
    buffer_load_dwordx4 v153, s[28:31], s48 offen offset:3072 nt lds
    s_waitcnt vmcnt(11)
    s_add_u32 m0, s49, 40960
    s_nop 0
    buffer_load_dwordx4 v154, s[28:31], s48 offen offset:0 nt lds
    s_waitcnt vmcnt(11)
    buffer_load_dwordx4 v155, s[28:31], s48 offen offset:1024 nt lds
    s_waitcnt vmcnt(11)
    buffer_load_dwordx4 v156, s[28:31], s48 offen offset:2048 nt lds
    s_waitcnt vmcnt(11)
    buffer_load_dwordx4 v157, s[28:31], s48 offen offset:3072 nt lds
    s_waitcnt vmcnt(11)
    s_add_u32 m0, s49, 45056
    s_nop 0
    buffer_load_dwordx4 v158, s[28:31], s48 offen offset:0 nt lds
    s_waitcnt vmcnt(11)
    s_add_u32 m0, s49, 73728
    s_add_u32 s48, s48, 36864
    buffer_load_dwordx4 v150, s[28:31], s48 offen offset:0 nt lds
    s_waitcnt vmcnt(11)
    buffer_load_dwordx4 v151, s[28:31], s48 offen offset:1024 nt lds
    s_waitcnt vmcnt(11)
    buffer_load_dwordx4 v152, s[28:31], s48 offen offset:2048 nt lds
    s_waitcnt vmcnt(12)
    s_barrier
    ds_read_b64_tr_b16 a[0:1], v160 offset:0
    ds_read_b64_tr_b16 a[2:3], v160 offset:18432
    ds_read_b64_tr_b16 a[4:5], v160 offset:128
    ds_read_b64_tr_b16 a[6:7], v160 offset:18560
    ds_read_b64_tr_b16 a[8:9], v160 offset:256
    ds_read_b64_tr_b16 a[10:11], v160 offset:18688
    ds_read_b64_tr_b16 a[12:13], v160 offset:384
    ds_read_b64_tr_b16 a[14:15], v160 offset:18816
    ds_read_b64_tr_b16 a[16:17], v160 offset:512
    ds_read_b64_tr_b16 a[18:19], v160 offset:18944
    ds_read_b64_tr_b16 a[20:21], v160 offset:640
    ds_read_b64_tr_b16 a[22:23], v160 offset:19072
    ds_read_b64_tr_b16 a[24:25], v160 offset:768
    ds_read_b64_tr_b16 a[26:27], v160 offset:19200
    ds_read_b64_tr_b16 a[28:29], v160 offset:896
    ds_read_b64_tr_b16 a[30:31], v160 offset:19328
    ds_read_b64_tr_b16 a[32:33], v160 offset:1024
    ds_read_b64_tr_b16 a[34:35], v160 offset:19456
    v_add_u32 v160, 36864, v160
    s_waitcnt vmcnt(11)
    buffer_load_dwordx4 v153, s[28:31], s48 offen offset:3072 nt lds
    s_waitcnt vmcnt(11)
    s_add_u32 m0, s49, 77824
    s_nop 0
    buffer_load_dwordx4 v154, s[28:31], s48 offen offset:0 nt lds
    s_waitcnt vmcnt(11)
    buffer_load_dwordx4 v155, s[28:31], s48 offen offset:1024 nt lds
    s_waitcnt vmcnt(11)
    buffer_load_dwordx4 v156, s[28:31], s48 offen offset:2048 nt lds
    s_waitcnt vmcnt(11)
    buffer_load_dwordx4 v157, s[28:31], s48 offen offset:3072 nt lds
    s_waitcnt vmcnt(11)
    s_add_u32 m0, s49, 81920
    s_nop 0
    buffer_load_dwordx4 v158, s[28:31], s48 offen offset:0 nt lds
    s_waitcnt vmcnt(11)
    s_add_u32 m0, s49, 110592
    s_add_u32 s48, s48, 36864
    buffer_load_dwordx4 v150, s[28:31], s48 offen offset:0 nt lds
    s_waitcnt vmcnt(11)
    buffer_load_dwordx4 v151, s[28:31], s48 offen offset:1024 nt lds
    s_waitcnt vmcnt(11)
    buffer_load_dwordx4 v152, s[28:31], s48 offen offset:2048 nt lds
    s_waitcnt vmcnt(12)
    s_barrier
    ds_read_b64_tr_b16 a[36:37], v160 offset:0
    ds_read_b64_tr_b16 a[38:39], v160 offset:18432
    ds_read_b64_tr_b16 a[40:41], v160 offset:128
    ds_read_b64_tr_b16 a[42:43], v160 offset:18560
    ds_read_b64_tr_b16 a[44:45], v160 offset:256
    ds_read_b64_tr_b16 a[46:47], v160 offset:18688
    ds_read_b64_tr_b16 a[48:49], v160 offset:384
    ds_read_b64_tr_b16 a[50:51], v160 offset:18816
    ds_read_b64_tr_b16 a[52:53], v160 offset:512
    ds_read_b64_tr_b16 a[54:55], v160 offset:18944
    ds_read_b64_tr_b16 a[56:57], v160 offset:640
    ds_read_b64_tr_b16 a[58:59], v160 offset:19072
    ds_read_b64_tr_b16 a[60:61], v160 offset:768
    ds_read_b64_tr_b16 a[62:63], v160 offset:19200
    ds_read_b64_tr_b16 a[64:65], v160 offset:896
    ds_read_b64_tr_b16 a[66:67], v160 offset:19328
    ds_read_b64_tr_b16 a[68:69], v160 offset:1024
    ds_read_b64_tr_b16 a[70:71], v160 offset:19456
    v_add_u32 v160, 36864, v160
    s_waitcnt vmcnt(11)
    buffer_load_dwordx4 v153, s[28:31], s48 offen offset:3072 nt lds
    s_waitcnt vmcnt(11)
    s_add_u32 m0, s49, 114688
    s_nop 0
    buffer_load_dwordx4 v154, s[28:31], s48 offen offset:0 nt lds
    s_waitcnt vmcnt(11)
    buffer_load_dwordx4 v155, s[28:31], s48 offen offset:1024 nt lds
    s_waitcnt vmcnt(11)
    buffer_load_dwordx4 v156, s[28:31], s48 offen offset:2048 nt lds
    s_waitcnt vmcnt(11)
    buffer_load_dwordx4 v157, s[28:31], s48 offen offset:3072 nt lds
    s_waitcnt vmcnt(11)
    s_add_u32 m0, s49, 118784
    s_nop 0
    buffer_load_dwordx4 v158, s[28:31], s48 offen offset:0 nt lds
    s_waitcnt vmcnt(9)
    s_barrier
    ds_read_b64_tr_b16 a[72:73], v160 offset:0
    ds_read_b64_tr_b16 a[74:75], v160 offset:18432
    ds_read_b64_tr_b16 a[76:77], v160 offset:128
    ds_read_b64_tr_b16 a[78:79], v160 offset:18560
    ds_read_b64_tr_b16 a[80:81], v160 offset:256
    ds_read_b64_tr_b16 a[82:83], v160 offset:18688
    ds_read_b64_tr_b16 a[84:85], v160 offset:384
    ds_read_b64_tr_b16 a[86:87], v160 offset:18816
    ds_read_b64_tr_b16 a[88:89], v160 offset:512
    ds_read_b64_tr_b16 a[90:91], v160 offset:18944
    ds_read_b64_tr_b16 a[92:93], v160 offset:640
    ds_read_b64_tr_b16 a[94:95], v160 offset:19072
    ds_read_b64_tr_b16 a[96:97], v160 offset:768
    ds_read_b64_tr_b16 a[98:99], v160 offset:19200
    ds_read_b64_tr_b16 a[100:101], v160 offset:896
    ds_read_b64_tr_b16 a[102:103], v160 offset:19328
    ds_read_b64_tr_b16 a[104:105], v160 offset:1024
    ds_read_b64_tr_b16 a[106:107], v160 offset:19456
    v_add_u32 v160, 36864, v160
    s_waitcnt vmcnt(0)
    s_barrier
    ds_read_b64_tr_b16 a[108:109], v160 offset:0
    ds_read_b64_tr_b16 a[110:111], v160 offset:18432
    ds_read_b64_tr_b16 a[112:113], v160 offset:128
    ds_read_b64_tr_b16 a[114:115], v160 offset:18560
    ds_read_b64_tr_b16 a[116:117], v160 offset:256
    ds_read_b64_tr_b16 a[118:119], v160 offset:18688
    ds_read_b64_tr_b16 a[120:121], v160 offset:384
    ds_read_b64_tr_b16 a[122:123], v160 offset:18816
    ds_read_b64_tr_b16 a[124:125], v160 offset:512
    ds_read_b64_tr_b16 a[126:127], v160 offset:18944
    ds_read_b64_tr_b16 a[128:129], v160 offset:640
    ds_read_b64_tr_b16 a[130:131], v160 offset:19072
    ds_read_b64_tr_b16 a[132:133], v160 offset:768
    ds_read_b64_tr_b16 a[134:135], v160 offset:19200
    ds_read_b64_tr_b16 a[136:137], v160 offset:896
    ds_read_b64_tr_b16 a[138:139], v160 offset:19328
    ds_read_b64_tr_b16 a[140:141], v160 offset:1024
    ds_read_b64_tr_b16 a[142:143], v160 offset:19456
    buffer_load_dwordx4 v[24:27], v248, s[16:19], s50 offen sc1
    s_mov_b32 s60, 60000
    s_waitcnt vmcnt(0)
Lp_13:
    v_xor_b32 v7, v236, v24
    v_bitop3_b32 v7, v7, v25, v237 bitop3:0xf6
    v_bitop3_b32 v7, v7, v26, v238 bitop3:0xf6
    v_bitop3_b32 v7, v7, v27, v239 bitop3:0xf6
    v_and_b32 v7, 0xff, v7
    v_cmp_ne_u32 vcc, 0, v7
    s_cbranch_vccz Lok_14
    s_sub_u32 s60, s60, 1
    s_cbranch_scc1 Lok_14
    s_cmp_le_u32 s60, 59976
    s_cselect_b32 s3, s60, 1
    s_and_b32 s3, s3, 15
    s_cselect_b32 s3, 0, 720896
    v_add_u32 v8, s3, v248
    buffer_load_dwordx4 v[24:27], v8, s[16:19], s50 offen sc1
    s_waitcnt vmcnt(0)
    s_branch Lp_13
Lok_14:
    v_add_f32_dpp v24, v24, v24 quad_perm:[1,0,3,2] row_mask:0xf bank_mask:0xf
    v_add_f32_dpp v25, v25, v25 quad_perm:[1,0,3,2] row_mask:0xf bank_mask:0xf
    v_add_f32_dpp v26, v26, v26 quad_perm:[1,0,3,2] row_mask:0xf bank_mask:0xf
    v_add_f32_dpp v27, v27, v27 quad_perm:[1,0,3,2] row_mask:0xf bank_mask:0xf
    v_add_f32_dpp v24, v24, v24 quad_perm:[2,3,0,1] row_mask:0xf bank_mask:0xf
    v_add_f32_dpp v25, v25, v25 quad_perm:[2,3,0,1] row_mask:0xf bank_mask:0xf
    v_add_f32_dpp v26, v26, v26 quad_perm:[2,3,0,1] row_mask:0xf bank_mask:0xf
    v_add_f32_dpp v27, v27, v27 quad_perm:[2,3,0,1] row_mask:0xf bank_mask:0xf
    v_cvt_pk_bf16_f32 v24, v24, v25
    v_cvt_pk_bf16_f32 v25, v26, v27
    ds_write_b64 v162, v[24:25]
    s_waitcnt lgkmcnt(0)
    s_barrier
    ds_read2_b64 v[24:27], v163 offset0:0 offset1:4
    ds_read2_b64 v[28:31], v163 offset0:8 offset1:12
    ds_read2_b64 v[32:35], v163 offset0:16 offset1:20
    ds_read2_b64 v[36:39], v163 offset0:24 offset1:28
    s_waitcnt lgkmcnt(3)
    v_mfma_f32_16x16x32_bf16 v[176:179], a[0:3], v[24:27], 0
    v_mfma_f32_16x16x32_bf16 v[180:183], a[4:7], v[24:27], 0
    v_mfma_f32_16x16x32_bf16 v[184:187], a[8:11], v[24:27], 0
    s_waitcnt lgkmcnt(2)
    v_mfma_f32_16x16x32_bf16 v[176:179], a[36:39], v[28:31], v[176:179]
    v_mfma_f32_16x16x32_bf16 v[180:183], a[40:43], v[28:31], v[180:183]
    v_mfma_f32_16x16x32_bf16 v[184:187], a[44:47], v[28:31], v[184:187]
    s_waitcnt lgkmcnt(1)
    v_mfma_f32_16x16x32_bf16 v[176:179], a[72:75], v[32:35], v[176:179]
    v_mfma_f32_16x16x32_bf16 v[180:183], a[76:79], v[32:35], v[180:183]
    v_mfma_f32_16x16x32_bf16 v[184:187], a[80:83], v[32:35], v[184:187]
    s_waitcnt lgkmcnt(0)
    v_mfma_f32_16x16x32_bf16 v[176:179], a[108:111], v[36:39], v[176:179]
    v_mfma_f32_16x16x32_bf16 v[180:183], a[112:115], v[36:39], v[180:183]
    v_mfma_f32_16x16x32_bf16 v[184:187], a[116:119], v[36:39], v[184:187]
    v_mfma_f32_16x16x32_bf16 v[188:191], a[12:15], v[24:27], 0
    v_mfma_f32_16x16x32_bf16 v[192:195], a[16:19], v[24:27], 0
    v_mfma_f32_16x16x32_bf16 v[196:199], a[20:23], v[24:27], 0
    v_mfma_f32_16x16x32_bf16 v[188:191], a[48:51], v[28:31], v[188:191]
    s_nop 2
    v_cndmask_b32 v176, v176, v180, s[22:23]
    v_cndmask_b32 v177, v177, v181, s[22:23]
    v_mfma_f32_16x16x32_bf16 v[192:195], a[52:55], v[28:31], v[192:195]
    v_cndmask_b32 v178, v178, v182, s[22:23]
    v_cndmask_b32 v179, v179, v183, s[22:23]
    v_mfma_f32_16x16x32_bf16 v[196:199], a[56:59], v[28:31], v[196:199]
    v_cndmask_b32 v176, v176, v184, s[58:59]
    v_cndmask_b32 v177, v177, v185, s[58:59]
    v_mfma_f32_16x16x32_bf16 v[188:191], a[84:87], v[32:35], v[188:191]
    v_cndmask_b32 v178, v178, v186, s[58:59]
    v_cndmask_b32 v179, v179, v187, s[58:59]
    v_mfma_f32_16x16x32_bf16 v[192:195], a[88:91], v[32:35], v[192:195]
    v_and_or_b32 v176, v176, v254, v236
    v_and_or_b32 v177, v177, v254, v237
    v_mfma_f32_16x16x32_bf16 v[196:199], a[92:95], v[32:35], v[196:199]
    v_and_or_b32 v178, v178, v254, v238
    v_and_or_b32 v179, v179, v254, v239
    v_mfma_f32_16x16x32_bf16 v[188:191], a[120:123], v[36:39], v[188:191]
    buffer_store_dwordx4 v[176:179], v161, s[16:19], s52 offen sc1
    v_mfma_f32_16x16x32_bf16 v[192:195], a[124:127], v[36:39], v[192:195]
    v_mfma_f32_16x16x32_bf16 v[196:199], a[128:131], v[36:39], v[196:199]
    v_mfma_f32_16x16x32_bf16 v[200:203], a[24:27], v[24:27], 0
    v_mfma_f32_16x16x32_bf16 v[204:207], a[28:31], v[24:27], 0
    v_mfma_f32_16x16x32_bf16 v[208:211], a[32:35], v[24:27], 0
    v_mfma_f32_16x16x32_bf16 v[200:203], a[60:63], v[28:31], v[200:203]
    s_nop 2
    v_cndmask_b32 v188, v188, v192, s[22:23]
    v_cndmask_b32 v189, v189, v193, s[22:23]
    v_mfma_f32_16x16x32_bf16 v[204:207], a[64:67], v[28:31], v[204:207]
    v_cndmask_b32 v190, v190, v194, s[22:23]
    v_cndmask_b32 v191, v191, v195, s[22:23]
    v_mfma_f32_16x16x32_bf16 v[208:211], a[68:71], v[28:31], v[208:211]
    v_cndmask_b32 v188, v188, v196, s[58:59]
    v_cndmask_b32 v189, v189, v197, s[58:59]
    v_mfma_f32_16x16x32_bf16 v[200:203], a[96:99], v[32:35], v[200:203]
    v_cndmask_b32 v190, v190, v198, s[58:59]
    v_cndmask_b32 v191, v191, v199, s[58:59]
    v_mfma_f32_16x16x32_bf16 v[204:207], a[100:103], v[32:35], v[204:207]
    v_and_or_b32 v188, v188, v254, v236
    v_and_or_b32 v189, v189, v254, v237
    v_mfma_f32_16x16x32_bf16 v[208:211], a[104:107], v[32:35], v[208:211]
    v_and_or_b32 v190, v190, v254, v238
    v_and_or_b32 v191, v191, v254, v239
    v_mfma_f32_16x16x32_bf16 v[200:203], a[132:135], v[36:39], v[200:203]
    buffer_store_dwordx4 v[188:191], v161, s[16:19], s53 offen sc1
    v_mfma_f32_16x16x32_bf16 v[204:207], a[136:139], v[36:39], v[204:207]
    v_mfma_f32_16x16x32_bf16 v[208:211], a[140:143], v[36:39], v[208:211]
    s_nop 6
    v_cndmask_b32 v200, v200, v204, s[22:23]
    v_cndmask_b32 v201, v201, v205, s[22:23]
    v_cndmask_b32 v202, v202, v206, s[22:23]
    v_cndmask_b32 v203, v203, v207, s[22:23]
    v_cndmask_b32 v200, v200, v208, s[58:59]
    v_cndmask_b32 v201, v201, v209, s[58:59]
    v_cndmask_b32 v202, v202, v210, s[58:59]
    v_cndmask_b32 v203, v203, v211, s[58:59]
    v_and_or_b32 v200, v200, v254, v236
    v_and_or_b32 v201, v201, v254, v237
    v_and_or_b32 v202, v202, v254, v238
    v_and_or_b32 v203, v203, v254, v239
    buffer_store_dwordx4 v[200:203], v161, s[16:19], s54 offen sc1
    s_endpgm
L_GB:
    s_load_dwordx2 s[40:41], s[0:1], 32
    s_mov_b32 s42, 4194304
    s_mov_b32 s43, 0x20000
    s_lshr_b32 s3, s12, 1
    s_lshl_b32 s46, s3, 17
    s_lshr_b32 s13, s3, 5
    s_and_b32 s14, s3, 31
    s_and_b32 s15, s11, 1
    s_lshl_b32 s45, s6, 15
    s_lshl_b32 s3, s6, 12
    s_add_u32 s46, s46, s3
    s_lshl_b32 s54, s13, 22
    s_lshl_b32 s55, s14, 10
    s_add_u32 s55, s55, s54
    s_add_u32 s54, s54, s3
    s_lshl_b32 s3, s6, 15
    s_add_u32 s55, s55, s3
    s_lshl_b32 s3, s15, 21
    s_and_b32 s3, s3, 0
    s_sub_u32 s54, s55, s3
    s_add_u32 s55, s55, s3
    v_lshlrev_b32 v7, 5, v3
    v_lshlrev_b32 v8, 4, v2
    v_xor_b32 v7, v7, v8
    v_lshl_add_u32 v120, v3, 13, v7
    v_xor_b32 v121, 0x80, v120
    s_mul_i32 s52, s8, 1179648
    s_mul_i32 s3, s6, 65536
    s_add_u32 s52, s52, s3
    s_lshl_b32 s3, s7, 8
    s_add_u32 s52, s52, s3
    s_add_u32 s52, s52, 917504
    s_mul_i32 s53, s6, 2048
    s_add_u32 s53, s53, 131072
    v_lshrrev_b32 v7, 5, v1
    v_mul_u32_u24 v7, 1152, v7
    v_and_b32 v8, 31, v1
    v_lshl_add_u32 v126, v8, 3, v7
    v_lshl_add_u32 v127, v8, 2, v7
    s_waitcnt lgkmcnt(0)
    s_add_u32 s4, s16, 4128768
    s_addc_u32 s5, s17, 0
    s_load_dwordx2 s[60:61], s[4:5], 0
    s_cmp_eq_u32 s6, 0
    s_cselect_b32 s26, s26, 0
    buffer_load_dwordx2 v[24:25], v126, s[24:27], 0 offen offset:0
    buffer_load_dwordx2 v[26:27], v126, s[24:27], 0 offen offset:256
    buffer_load_dwordx2 v[28:29], v126, s[24:27], 0 offen offset:512
    buffer_load_dwordx2 v[30:31], v126, s[24:27], 0 offen offset:768
    buffer_load_dword v32, v127, s[24:27], 0 offen offset:1024
    s_movk_i32 s26, 2304
    s_add_u32 m0, s53, 0
    s_nop 0
    buffer_load_dwordx4 v120, s[28:31], s52 offen nt lds
    s_add_u32 m0, s53, 1024
    s_add_u32 s52, s52, 32768
    buffer_load_dwordx4 v121, s[28:31], s52 offen nt lds
    s_lshl_b32 s44, s8, 20
    s_lshl_b32 s3, s6, 18
    s_add_u32 s44, s44, s3
    s_lshl_b32 s3, s7, 8
    s_add_u32 s44, s44, s3
    s_lshl_b32 s3, s6, 6
    v_lshlrev_b32 v8, 4, v2
    v_xor_b32 v7, s3, v8
    v_lshl_add_u32 v12, v3, 13, v7
    v_xor_b32 v13, 32, v12
    s_add_u32 m0, s45, 16384
    s_nop 0
    buffer_load_dwordx4 v12, s[40:43], s44 offen nt lds
    s_add_u32 m0, s45, 17408
    s_add_u32 s44, s44, 32768
    buffer_load_dwordx4 v12, s[40:43], s44 offen nt lds
    s_add_u32 m0, s45, 18432
    s_add_u32 s44, s44, 32768
    buffer_load_dwordx4 v12, s[40:43], s44 offen nt lds
    s_add_u32 m0, s45, 19456
    s_add_u32 s44, s44, 32768
    buffer_load_dwordx4 v12, s[40:43], s44 offen nt lds
    s_add_u32 m0, s45, 20480
    s_add_u32 s44, s44, 32768
    buffer_load_dwordx4 v13, s[40:43], s44 offen nt lds
    s_add_u32 m0, s45, 21504
    s_add_u32 s44, s44, 32768
    buffer_load_dwordx4 v13, s[40:43], s44 offen nt lds
    s_add_u32 m0, s45, 22528
    s_add_u32 s44, s44, 32768
    buffer_load_dwordx4 v13, s[40:43], s44 offen nt lds
    s_add_u32 m0, s45, 23552
    s_add_u32 s44, s44, 32768
    buffer_load_dwordx4 v13, s[40:43], s44 offen nt lds
    v_xor_b32 v16, 0, v6
    v_xor_b32 v17, 32, v6
    v_xor_b32 v18, 64, v6
    v_xor_b32 v19, 96, v6
    v_xor_b32 v20, 128, v6
    v_xor_b32 v21, 160, v6
    v_xor_b32 v22, 192, v6
    v_xor_b32 v23, 224, v6
    s_load_dwordx2 s[28:29], s[0:1], 80
    s_mov_b32 s30, 2304
    s_mov_b32 s31, 0x20000
    v_lshrrev_b32 v4, 2, v2
    v_and_b32 v5, 3, v1
    v_lshlrev_b32 v5, 3, v5
    v_mov_b32 v254, 0xffffff00
    v_mov_b32 v255, 0x00010001
    v_mov_b32 v252, 0x07060302
    v_mov_b32 v251, 2130706432
    v_and_b32 v7, 1, v2
    v_cmp_ne_u32 s[62:63], 0, v7
    v_and_b32 v8, 2, v2
    v_cmp_ne_u32 s[22:23], 0, v8
    v_and_b32 v10, 4, v2
    v_cmp_ne_u32 s[58:59], 0, v10
    v_lshlrev_b32 v7, 7, v7
    v_lshl_add_u32 v7, v8, 5, v7
    v_lshl_add_u32 v7, v3, 4, v7
    v_cmp_gt_u32 vcc, 4, v2
    s_nop 1
    v_cndmask_b32 v247, v251, v7, vcc
    v_lshlrev_b32 v7, 5, v5
    v_lshl_add_u32 v7, v10, 5, v7
    v_lshrrev_b32 v8, 3, v2
    v_lshl_add_u32 v7, v8, 6, v7
    v_lshl_add_u32 v248, v3, 4, v7
    v_and_b32 v7, 1, v3
    v_lshl_add_u32 v250, v7, 2, v4
    v_lshl_add_u32 v249, v250, 5, v5
    s_lshl_b32 s44, s8, 20
    s_lshl_b32 s3, s6, 18
    s_add_u32 s44, s44, s3
    s_lshl_b32 s3, s7, 8
    s_add_u32 s44, s44, s3
    s_lshl_b32 s3, s6, 6
    v_lshlrev_b32 v8, 4, v2
    v_xor_b32 v7, s3, v8
    v_lshl_add_u32 v12, v3, 13, v7
    v_xor_b32 v13, 32, v12
    v_xor_b32 v7, s3, v249
    v_lshl_add_u32 v8, v3, 2, v4
    v_lshl_add_u32 v7, v8, 8, v7
    v_add_u32 v116, 131072, v7
    v_xor_b32 v117, 32, v116
    v_and_b32 v7, 1, v2
    v_mul_u32_u24 v8, 1152, v7
    v_lshl_add_u32 v7, v3, 3, v8
    s_mul_i32 s3, s8, 288
    s_add_u32 s3, s3, 152800
    v_add_u32 v118, s3, v7
    v_lshrrev_b32 v7, 1, v3
    v_and_b32 v8, 7, v2
    v_xor_b32 v7, v7, v8
    v_lshlrev_b32 v7, 5, v7
    v_and_b32 v8, 1, v3
    v_lshl_add_u32 v7, v8, 4, v7
    v_lshl_add_u32 v7, v2, 10, v7
    v_add_u32 v80, s45, v7
    v_add_u32 v84, 131072, v7
    v_xor_b32 v81, 64, v80
    v_xor_b32 v85, 64, v84
    v_xor_b32 v82, 128, v80
    v_xor_b32 v86, 128, v84
    v_xor_b32 v83, 192, v80
    v_xor_b32 v87, 192, v84
    v_lshl_add_u32 v8, v3, 2, v4
    v_lshl_add_u32 v7, v8, 10, v249
    s_lshl_b32 s3, s6, 8
    v_add_u32 v88, s3, v7
    v_xor_b32 v89, 32, v88
    v_xor_b32 v90, 64, v88
    v_xor_b32 v91, 96, v88
    v_xor_b32 v92, 128, v88
    v_xor_b32 v93, 160, v88
    v_xor_b32 v94, 192, v88
    v_xor_b32 v95, 224, v88
    s_and_b32 s3, s6, 1
    s_lshl_b32 s3, s3, 7
    v_xor_b32 v7, s3, v6
    s_lshl_b32 s3, s6, 12
    s_add_u32 s3, s3, 131072
    v_add_u32 v100, s3, v7
    v_xor_b32 v101, 32, v100
    v_xor_b32 v102, 64, v100
    v_xor_b32 v103, 96, v100
    s_lshl_b32 s3, s6, 2
    s_add_u32 s3, s3, 147456
    v_lshl_add_u32 v104, v2, 4, s3
    v_lshlrev_b32 v105, 4, v2
    v_lshrrev_b32 v8, 4, v0
    v_cmp_eq_u32 vcc, v8, v4
    s_nop 1
    v_cndmask_b32 v109, v251, v105, vcc
    v_add_u32 v105, 147456, v105
    s_lshl_b32 s3, s6, 10
    s_add_u32 s3, s3, 148480
    v_add_u32 v106, s3, v6
    v_add_u32 v107, 148480, v6
    v_lshlrev_b32 v7, 18, v3
    v_lshl_add_u32 v108, v2, 4, v7
    s_lshl_b32 s56, s12, 8
    s_add_u32 s56, s56, 3604480
    s_lshl_b32 s48, s13, 15
    s_lshl_b32 s3, s15, 14
    s_add_u32 s48, s48, s3
    s_lshl_b32 s3, s6, 12
    s_add_u32 s48, s48, s3
    s_add_u32 s48, s48, 3538944
    s_lshl_b32 s57, s15, 10
    s_lshl_b32 s3, s6, 8
    s_add_u32 s57, s57, s3
    s_lshr_b32 s3, s12, 1
    s_lshl_b32 s3, s3, 2
    s_add_u32 s57, s57, s3
    s_add_u32 s57, s57, 3637248
    v_cmp_eq_u32 vcc, 0, v1
    s_nop 1
    v_cndmask_b32 v99, v251, v1, vcc
    v_mov_b32 v112, 0x3f803f80
    v_mov_b32 v113, 0x3f803f80
    v_mov_b32 v114, 0x3f803f80
    v_mov_b32 v115, 0x3f803f80
    s_lshl_b32 s51, s6, 13
    s_add_u32 s51, s51, 0
    s_lshl_b32 s49, s7, 12
    s_lshl_b32 s3, s6, 10
    s_add_u32 s49, s49, s3
    s_add_u32 s49, s49, 2359296
    s_lshl_b32 s3, s8, 8
    s_add_u32 s50, s49, s3
    s_lshl_b32 s10, s7, 13
    s_lshl_b32 s4, s6, 11
    s_add_u32 s10, s10, s4
    s_add_u32 s10, s10, s3
    s_add_u32 s10, s10, 2098176
    s_lshl_b32 s3, s11, 4
    v_add_u32 v7, s3, v0
    v_lshlrev_b32 v7, 7, v7
    v_cmp_gt_u32 vcc, 16, v0
    s_nop 1
    v_cndmask_b32 v7, v251, v7, vcc
    s_lshl_b32 s3, s13, 15
    s_add_u32 s3, s3, 3538944
    buffer_load_dword v9, v7, s[16:19], s3 offen sc1
    s_cmp_eq_u32 s6, 0
    s_cbranch_scc0 Lw_16
    s_waitcnt vmcnt(11)
    v_add_u32 v126, 152576, v126
    v_add_u32 v127, 152576, v127
    v_lshlrev_b32 v34, 16, v24
    v_and_b32 v35, 0xffff0000, v24
    v_lshlrev_b32 v36, 16, v25
    v_and_b32 v37, 0xffff0000, v25
    v_lshlrev_b32 v38, 16, v26
    v_and_b32 v39, 0xffff0000, v26
    v_lshlrev_b32 v40, 16, v27
    v_and_b32 v41, 0xffff0000, v27
    v_lshlrev_b32 v42, 16, v28
    v_and_b32 v43, 0xffff0000, v28
    v_lshlrev_b32 v44, 16, v29
    v_and_b32 v45, 0xffff0000, v29
    v_lshlrev_b32 v46, 16, v30
    v_and_b32 v47, 0xffff0000, v30
    v_lshlrev_b32 v48, 16, v31
    v_and_b32 v49, 0xffff0000, v31
    v_lshlrev_b32 v50, 16, v32
    v_and_b32 v51, 0xffff0000, v32
    v_pk_add_f32 v[52:53], v[34:35], v[36:37]
    v_pk_add_f32 v[54:55], v[38:39], v[40:41]
    v_pk_add_f32 v[52:53], v[52:53], v[42:43]
    v_pk_add_f32 v[54:55], v[54:55], v[44:45]
    v_pk_add_f32 v[52:53], v[52:53], v[46:47]
    v_pk_add_f32 v[54:55], v[54:55], v[48:49]
    v_pk_add_f32 v[52:53], v[52:53], v[50:51]
    v_pk_add_f32 v[52:53], v[52:53], v[54:55]
    v_add_f32 v52, v52, v53
    s_nop 1
    v_add_f32_dpp v52, v52, v52 row_ror:8 row_mask:0xf bank_mask:0xf
    s_nop 1
    v_add_f32_dpp v52, v52, v52 row_ror:4 row_mask:0xf bank_mask:0xf
    s_nop 1
    v_add_f32_dpp v52, v52, v52 row_ror:2 row_mask:0xf bank_mask:0xf
    s_nop 1
    v_add_f32_dpp v52, v52, v52 row_ror:1 row_mask:0xf bank_mask:0xf
    v_mov_b32 v53, v52
    s_nop 1
    v_permlane16_swap_b32 v52, v53
    v_add_f32 v52, v52, v53
    v_mul_f32 v52, 0x3ae38e39, v52
    v_cvt_pk_bf16_f32 v54, v52, v52
    v_mov_b32 v53, v52
    v_and_b32 v54, 0xffff0000, v54
    v_mov_b32 v55, v54
    v_pk_add_f32 v[56:57], v[34:35], v[52:53] neg_lo:[0,1] neg_hi:[0,1]
    v_pk_add_f32 v[58:59], v[36:37], v[52:53] neg_lo:[0,1] neg_hi:[0,1]
    v_pk_add_f32 v[60:61], v[38:39], v[52:53] neg_lo:[0,1] neg_hi:[0,1]
    v_pk_add_f32 v[62:63], v[40:41], v[52:53] neg_lo:[0,1] neg_hi:[0,1]
    v_pk_add_f32 v[64:65], v[42:43], v[52:53] neg_lo:[0,1] neg_hi:[0,1]
    v_pk_add_f32 v[66:67], v[44:45], v[52:53] neg_lo:[0,1] neg_hi:[0,1]
    v_pk_add_f32 v[68:69], v[46:47], v[52:53] neg_lo:[0,1] neg_hi:[0,1]
    v_pk_add_f32 v[70:71], v[48:49], v[52:53] neg_lo:[0,1] neg_hi:[0,1]
    v_pk_add_f32 v[72:73], v[50:51], v[52:53] neg_lo:[0,1] neg_hi:[0,1]
    v_pk_mul_f32 v[74:75], v[56:57], v[56:57]
    v_pk_mul_f32 v[76:77], v[58:59], v[58:59]
    v_pk_fma_f32 v[74:75], v[60:61], v[60:61], v[74:75]
    v_pk_fma_f32 v[76:77], v[62:63], v[62:63], v[76:77]
    v_pk_fma_f32 v[74:75], v[64:65], v[64:65], v[74:75]
    v_pk_fma_f32 v[76:77], v[66:67], v[66:67], v[76:77]
    v_pk_fma_f32 v[74:75], v[68:69], v[68:69], v[74:75]
    v_pk_fma_f32 v[76:77], v[70:71], v[70:71], v[76:77]
    v_pk_fma_f32 v[74:75], v[72:73], v[72:73], v[74:75]
    v_pk_add_f32 v[74:75], v[74:75], v[76:77]
    v_add_f32 v74, v74, v75
    v_pk_add_f32 v[56:57], v[34:35], v[54:55] neg_lo:[0,1] neg_hi:[0,1]
    v_pk_add_f32 v[58:59], v[36:37], v[54:55] neg_lo:[0,1] neg_hi:[0,1]
    v_add_f32_dpp v74, v74, v74 row_ror:8 row_mask:0xf bank_mask:0xf
    v_pk_add_f32 v[60:61], v[38:39], v[54:55] neg_lo:[0,1] neg_hi:[0,1]
    v_pk_add_f32 v[62:63], v[40:41], v[54:55] neg_lo:[0,1] neg_hi:[0,1]
    v_add_f32_dpp v74, v74, v74 row_ror:4 row_mask:0xf bank_mask:0xf
    v_pk_add_f32 v[64:65], v[42:43], v[54:55] neg_lo:[0,1] neg_hi:[0,1]
    v_pk_add_f32 v[66:67], v[44:45], v[54:55] neg_lo:[0,1] neg_hi:[0,1]
    v_add_f32_dpp v74, v74, v74 row_ror:2 row_mask:0xf bank_mask:0xf
    v_pk_add_f32 v[68:69], v[46:47], v[54:55] neg_lo:[0,1] neg_hi:[0,1]
    v_pk_add_f32 v[70:71], v[48:49], v[54:55] neg_lo:[0,1] neg_hi:[0,1]
    v_add_f32_dpp v74, v74, v74 row_ror:1 row_mask:0xf bank_mask:0xf
    v_pk_add_f32 v[72:73], v[50:51], v[54:55] neg_lo:[0,1] neg_hi:[0,1]
    v_cvt_pk_bf16_f32 v24, v56, v57
    v_mov_b32 v75, v74
    v_cvt_pk_bf16_f32 v25, v58, v59
    v_cvt_pk_bf16_f32 v26, v60, v61
    v_permlane16_swap_b32 v74, v75
    v_cvt_pk_bf16_f32 v27, v62, v63
    v_cvt_pk_bf16_f32 v28, v64, v65
    v_add_f32 v74, v74, v75
    v_cvt_pk_bf16_f32 v29, v66, v67
    v_cvt_pk_bf16_f32 v30, v68, v69
    v_mul_f32 v74, 0x3ae38e39, v74
    v_cvt_pk_bf16_f32 v31, v70, v71
    v_cvt_pk_bf16_f32 v32, v72, v73
    v_cvt_pk_bf16_f32 v74, v74, v74
    v_lshlrev_b32 v34, 16, v24
    v_and_b32 v35, 0xffff0000, v24
    v_and_b32 v74, 0xffff0000, v74
    v_lshlrev_b32 v36, 16, v25
    v_and_b32 v37, 0xffff0000, v25
    v_add_f32 v74, 0x3727c5ac, v74
    v_lshlrev_b32 v38, 16, v26
    v_and_b32 v39, 0xffff0000, v26
    v_cvt_pk_bf16_f32 v74, v74, v74
    v_lshlrev_b32 v40, 16, v27
    v_and_b32 v41, 0xffff0000, v27
    v_and_b32 v74, 0xffff0000, v74
    v_lshlrev_b32 v42, 16, v28
    v_and_b32 v43, 0xffff0000, v28
    v_sqrt_f32 v74, v74
    v_lshlrev_b32 v44, 16, v29
    v_and_b32 v45, 0xffff0000, v29
    v_cvt_pk_bf16_f32 v74, v74, v74
    v_lshlrev_b32 v46, 16, v30
    v_and_b32 v47, 0xffff0000, v30
    v_and_b32 v74, 0xffff0000, v74
    v_lshlrev_b32 v48, 16, v31
    v_and_b32 v49, 0xffff0000, v31
    v_rcp_f32 v74, v74
    v_lshlrev_b32 v50, 16, v32
    v_and_b32 v51, 0xffff0000, v32
    v_mov_b32 v75, v74
    v_pk_mul_f32 v[34:35], v[34:35], v[74:75]
    v_pk_mul_f32 v[36:37], v[36:37], v[74:75]
    v_pk_mul_f32 v[38:39], v[38:39], v[74:75]
    v_pk_mul_f32 v[40:41], v[40:41], v[74:75]
    v_pk_mul_f32 v[42:43], v[42:43], v[74:75]
    v_pk_mul_f32 v[44:45], v[44:45], v[74:75]
    v_pk_mul_f32 v[46:47], v[46:47], v[74:75]
    v_pk_mul_f32 v[48:49], v[48:49], v[74:75]
    v_pk_mul_f32 v[50:51], v[50:51], v[74:75]
    v_cvt_pk_bf16_f32 v24, v34, v35
    v_cvt_pk_bf16_f32 v25, v36, v37
    ds_write_b64 v126, v[24:25] offset:0
    v_cvt_pk_bf16_f32 v26, v38, v39
    v_cvt_pk_bf16_f32 v27, v40, v41
    ds_write_b64 v126, v[26:27] offset:256
    v_cvt_pk_bf16_f32 v28, v42, v43
    v_cvt_pk_bf16_f32 v29, v44, v45
    ds_write_b64 v126, v[28:29] offset:512
    v_cvt_pk_bf16_f32 v30, v46, v47
    v_cvt_pk_bf16_f32 v31, v48, v49
    ds_write_b64 v126, v[30:31] offset:768
    v_cvt_pk_bf16_f32 v32, v50, v51
    ds_write_b32 v127, v32 offset:1024
    s_waitcnt vmcnt(9)
    s_waitcnt lgkmcnt(0)
    s_barrier
    ds_read2_b64 v[128:131], v118 offset0:0 offset1:4
    ds_read_b64_tr_b16 v[140:141], v116 offset:0
    ds_read_b64_tr_b16 v[142:143], v116 offset:4096
    ds_read_b64_tr_b16 v[146:147], v117 offset:0
    ds_read_b64_tr_b16 v[148:149], v117 offset:4096
    s_add_u32 s100, s60, 0x9e3779b1
    s_and_b32 s3, s61, 0x55
    s_lshl_b32 s3, s3, 1
    s_xor_b32 s61, s61, s3
    s_xor_b32 s61, s61, 0x55
    s_and_b32 s61, s61, 0xff
    s_and_b32 s3, s61, 4
    s_lshl_b32 s3, s3, 1
    s_or_b32 s60, s3, 4
    s_lshr_b32 s3, s61, 4
    s_xor_b32 s3, s3, s61
    s_and_b32 s3, s3, 15
    s_cselect_b32 s60, 0, s60
    s_xor_b32 s61, s61, s60
    v_bfe_u32 v236, s100, 0, 8
    v_bfe_u32 v237, s100, 8, 8
    v_bfe_u32 v238, s100, 16, 8
    v_bfe_u32 v239, s100, 24, 8
    s_bfe_u32 s3, s61, 65537
    s_lshl_b32 s3, s3, 16
    s_bfe_u32 s96, s61, 65536
    s_or_b32 s96, s96, s3
    s_bfe_u32 s3, s61, 65539
    s_lshl_b32 s3, s3, 16
    s_bfe_u32 s97, s61, 65538
    s_or_b32 s97, s97, s3
    s_bfe_u32 s3, s61, 65541
    s_lshl_b32 s3, s3, 16
    s_bfe_u32 s98, s61, 65540
    s_or_b32 s98, s98, s3
    s_bfe_u32 s3, s61, 65543
    s_lshl_b32 s3, s3, 16
    s_bfe_u32 s99, s61, 65542
    s_or_b32 s99, s99, s3
    s_waitcnt lgkmcnt(0)
    v_mfma_f32_16x16x32_bf16 v[160:163], v[140:143], v[128:131], 0
    v_mfma_f32_16x16x32_bf16 v[164:167], v[146:149], v[128:131], 0
    s_nop 7
    v_cndmask_b32 v160, v160, v164, s[22:23]
    v_cndmask_b32 v161, v161, v165, s[22:23]
    v_cndmask_b32 v162, v162, v166, s[22:23]
    v_cndmask_b32 v163, v163, v167, s[22:23]
    v_and_or_b32 v160, v160, v254, v236
    v_and_or_b32 v161, v161, v254, v237
    v_and_or_b32 v162, v162, v254, v238
    v_and_or_b32 v163, v163, v254, v239
    buffer_store_dwordx4 v[160:163], v247, s[16:19], s10 offen
    s_add_u32 s3, s10, 720896
    buffer_store_dwordx4 v[160:163], v247, s[16:19], s3 offen sc1
    s_add_u32 m0, s45, 0
    s_add_u32 s47, s55, 0
    buffer_load_dwordx4 v16, s[36:39], s47 offen offset:0 nt lds
    s_add_u32 m0, s45, 1024
    s_add_u32 s47, s55, 131072
    buffer_load_dwordx4 v17, s[36:39], s47 offen offset:0 nt lds
    s_add_u32 m0, s45, 2048
    s_add_u32 s47, s55, 262144
    buffer_load_dwordx4 v18, s[36:39], s47 offen offset:0 nt lds
    s_add_u32 m0, s45, 3072
    s_add_u32 s47, s55, 393216
    buffer_load_dwordx4 v19, s[36:39], s47 offen offset:0 nt lds
    s_branch Lw_17
Lw_16:
    s_add_u32 m0, s45, 0
    s_add_u32 s47, s55, 0
    buffer_load_dwordx4 v16, s[36:39], s47 offen offset:0 nt lds
    s_add_u32 m0, s45, 1024
    s_add_u32 s47, s55, 131072
    buffer_load_dwordx4 v17, s[36:39], s47 offen offset:0 nt lds
    s_add_u32 m0, s45, 2048
    s_add_u32 s47, s55, 262144
    buffer_load_dwordx4 v18, s[36:39], s47 offen offset:0 nt lds
    s_add_u32 m0, s45, 3072
    s_add_u32 s47, s55, 393216
    buffer_load_dwordx4 v19, s[36:39], s47 offen offset:0 nt lds
    s_waitcnt vmcnt(13)
    s_waitcnt lgkmcnt(0)
    s_barrier
    ds_read2_b64 v[128:131], v118 offset0:0 offset1:4
    ds_read_b64_tr_b16 v[140:141], v116 offset:0
    ds_read_b64_tr_b16 v[142:143], v116 offset:4096
    ds_read_b64_tr_b16 v[146:147], v117 offset:0
    ds_read_b64_tr_b16 v[148:149], v117 offset:4096
    s_add_u32 s100, s60, 0x9e3779b1
    s_and_b32 s3, s61, 0x55
    s_lshl_b32 s3, s3, 1
    s_xor_b32 s61, s61, s3
    s_xor_b32 s61, s61, 0x55
    s_and_b32 s61, s61, 0xff
    s_and_b32 s3, s61, 4
    s_lshl_b32 s3, s3, 1
    s_or_b32 s60, s3, 4
    s_lshr_b32 s3, s61, 4
    s_xor_b32 s3, s3, s61
    s_and_b32 s3, s3, 15
    s_cselect_b32 s60, 0, s60
    s_xor_b32 s61, s61, s60
    v_bfe_u32 v236, s100, 0, 8
    v_bfe_u32 v237, s100, 8, 8
    v_bfe_u32 v238, s100, 16, 8
    v_bfe_u32 v239, s100, 24, 8
    s_bfe_u32 s3, s61, 65537
    s_lshl_b32 s3, s3, 16
    s_bfe_u32 s96, s61, 65536
    s_or_b32 s96, s96, s3
    s_bfe_u32 s3, s61, 65539
    s_lshl_b32 s3, s3, 16
    s_bfe_u32 s97, s61, 65538
    s_or_b32 s97, s97, s3
    s_bfe_u32 s3, s61, 65541
    s_lshl_b32 s3, s3, 16
    s_bfe_u32 s98, s61, 65540
    s_or_b32 s98, s98, s3
    s_bfe_u32 s3, s61, 65543
    s_lshl_b32 s3, s3, 16
    s_bfe_u32 s99, s61, 65542
    s_or_b32 s99, s99, s3
    s_waitcnt lgkmcnt(0)
    v_mfma_f32_16x16x32_bf16 v[160:163], v[140:143], v[128:131], 0
    v_mfma_f32_16x16x32_bf16 v[164:167], v[146:149], v[128:131], 0
    s_nop 7
    v_cndmask_b32 v160, v160, v164, s[22:23]
    v_cndmask_b32 v161, v161, v165, s[22:23]
    v_cndmask_b32 v162, v162, v166, s[22:23]
    v_cndmask_b32 v163, v163, v167, s[22:23]
    v_and_or_b32 v160, v160, v254, v236
    v_and_or_b32 v161, v161, v254, v237
    v_and_or_b32 v162, v162, v254, v238
    v_and_or_b32 v163, v163, v254, v239
    buffer_store_dwordx4 v[160:163], v247, s[16:19], s10 offen
    s_add_u32 s3, s10, 720896
    buffer_store_dwordx4 v[160:163], v247, s[16:19], s3 offen sc1
Lw_17:
    s_add_u32 m0, s45, 4096
    s_add_u32 s47, s55, 524288
    buffer_load_dwordx4 v20, s[36:39], s47 offen offset:0 nt lds
    s_add_u32 m0, s45, 5120
    s_add_u32 s47, s55, 655360
    buffer_load_dwordx4 v21, s[36:39], s47 offen offset:0 nt lds
    s_add_u32 m0, s45, 6144
    s_add_u32 s47, s55, 786432
    buffer_load_dwordx4 v22, s[36:39], s47 offen offset:0 nt lds
    s_add_u32 m0, s45, 7168
    s_add_u32 s47, s55, 917504
    buffer_load_dwordx4 v23, s[36:39], s47 offen offset:0 nt lds
    s_add_u32 m0, s45, 8192
    s_add_u32 s47, s55, 1048576
    buffer_load_dwordx4 v16, s[36:39], s47 offen offset:0 nt lds
    s_add_u32 m0, s45, 9216
    s_add_u32 s47, s55, 1179648
    buffer_load_dwordx4 v17, s[36:39], s47 offen offset:0 nt lds
    s_add_u32 m0, s45, 10240
    s_add_u32 s47, s55, 1310720
    buffer_load_dwordx4 v18, s[36:39], s47 offen offset:0 nt lds
    s_add_u32 m0, s45, 11264
    s_add_u32 s47, s55, 1441792
    buffer_load_dwordx4 v19, s[36:39], s47 offen offset:0 nt lds
    s_add_u32 m0, s45, 12288
    s_add_u32 s47, s55, 1572864
    buffer_load_dwordx4 v20, s[36:39], s47 offen offset:0 nt lds
    s_add_u32 m0, s45, 13312
    s_add_u32 s47, s55, 1703936
    buffer_load_dwordx4 v21, s[36:39], s47 offen offset:0 nt lds
    s_add_u32 m0, s45, 14336
    s_add_u32 s47, s55, 1835008
    buffer_load_dwordx4 v22, s[36:39], s47 offen offset:0 nt lds
    s_add_u32 m0, s45, 15360
    s_add_u32 s47, s55, 1966080
    buffer_load_dwordx4 v23, s[36:39], s47 offen offset:0 nt lds
    s_getreg_b32 s3, hwreg(HW_REG_XCC_ID, 0, 4)
    s_add_u32 s3, s3, s100
    v_mov_b32 v10, s3
    s_lshr_b32 s3, s2, 3
    s_lshl_b32 s3, s3, 2
    s_lshl_b32 s4, s9, 7
    s_add_u32 s3, s3, s4
    s_add_u32 s3, s3, 3653632
    v_cmp_eq_u32 vcc, 0, v0
    s_nop 1
    v_cndmask_b32 v7, v251, v0, vcc
    buffer_store_dword v10, v7, s[16:19], s3 offen sc1
    s_and_b32 s3, s12, 1
    s_or_b32 s3, s3, s6
    s_cselect_b32 s3, 72, s12
    s_cmp_ge_u32 s3, 72
    s_cselect_b32 s4, 2130706432, 0
    s_lshl_b32 s3, s12, 4
    s_or_b32 s3, s3, s4
    v_mov_b32 v7, s3
    buffer_load_dword v9, v7, s[28:31], 0 offen
    s_lshl_b32 s3, s11, 2
    v_add_u32 v7, s3, v0
    v_lshlrev_b32 v7, 9, v7
    v_cmp_gt_u32 vcc, 4, v0
    s_nop 1
    v_cndmask_b32 v7, v251, v7, vcc
    s_lshl_b32 s3, s7, 4
    s_add_u32 s3, s3, 3604480
    buffer_load_dword v9, v7, s[16:19], s3 offen sc1
    v_and_b32 v7, 31, v1
    v_lshlrev_b32 v7, 7, v7
    v_lshrrev_b32 v8, 5, v1
    v_mul_u32_u24 v8, 163840, v8
    v_add_u32 v7, v7, v8
    s_and_b32 s3, s12, 1
    s_or_b32 s3, s3, s6
    s_cselect_b32 s3, 72, s12
    s_cmp_ge_u32 s3, 72
    s_cselect_b32 s4, 2130706432, 0
    v_or_b32 v7, s4, v7
    s_lshl_b32 s3, s12, 11
    s_add_u32 s3, s3, 3670016
    buffer_load_dword v9, v7, s[16:19], s3 offen sc1
    v_lshrrev_b32 v7, 1, v250
    v_lshlrev_b32 v7, 15, v7
    v_and_b32 v8, 1, v4
    v_lshl_add_u32 v7, v8, 12, v7
    v_lshrrev_b32 v8, 1, v3
    v_lshl_add_u32 v7, v8, 8, v7
    s_lshl_b32 s3, s6, 6
    v_xor_b32 v8, s3, v249
    v_add_u32 v7, v7, v8
    v_add_u32 v96, 0x4000, v7
    v_xor_b32 v97, 32, v96
    s_waitcnt vmcnt(23)
    s_barrier
    ds_read_b64_tr_b16 v[40:41], v96 offset:0
    ds_read_b64_tr_b16 v[42:43], v96 offset:512
    ds_read_b64_tr_b16 v[44:45], v96 offset:1024
    ds_read_b64_tr_b16 v[46:47], v96 offset:1536
    ds_read_b64_tr_b16 v[48:49], v96 offset:2048
    ds_read_b64_tr_b16 v[50:51], v96 offset:2560
    ds_read_b64_tr_b16 v[52:53], v96 offset:3072
    ds_read_b64_tr_b16 v[54:55], v96 offset:3584
    ds_read_b64_tr_b16 v[56:57], v97 offset:0
    ds_read_b64_tr_b16 v[58:59], v97 offset:512
    ds_read_b64_tr_b16 v[60:61], v97 offset:1024
    ds_read_b64_tr_b16 v[62:63], v97 offset:1536
    ds_read_b64_tr_b16 v[64:65], v97 offset:2048
    ds_read_b64_tr_b16 v[66:67], v97 offset:2560
    ds_read_b64_tr_b16 v[68:69], v97 offset:3072
    ds_read_b64_tr_b16 v[70:71], v97 offset:3584
    s_waitcnt lgkmcnt(0)
    s_barrier
    s_add_u32 m0, s45, 16384
    s_add_u32 s47, s55, 2097152
    buffer_load_dwordx4 v16, s[36:39], s47 offen offset:0 nt lds
    s_add_u32 m0, s45, 17408
    s_add_u32 s47, s55, 2228224
    buffer_load_dwordx4 v17, s[36:39], s47 offen offset:0 nt lds
    s_add_u32 m0, s45, 18432
    s_add_u32 s47, s55, 2359296
    buffer_load_dwordx4 v18, s[36:39], s47 offen offset:0 nt lds
    s_add_u32 m0, s45, 19456
    s_add_u32 s47, s55, 2490368
    buffer_load_dwordx4 v19, s[36:39], s47 offen offset:0 nt lds
    s_add_u32 m0, s45, 20480
    s_add_u32 s47, s55, 2621440
    buffer_load_dwordx4 v20, s[36:39], s47 offen offset:0 nt lds
    s_add_u32 m0, s45, 21504
    s_add_u32 s47, s55, 2752512
    buffer_load_dwordx4 v21, s[36:39], s47 offen offset:0 nt lds
    s_add_u32 m0, s45, 22528
    s_add_u32 s47, s55, 2883584
    buffer_load_dwordx4 v22, s[36:39], s47 offen offset:0 nt lds
    s_add_u32 m0, s45, 23552
    s_add_u32 s47, s55, 3014656
    buffer_load_dwordx4 v23, s[36:39], s47 offen offset:0 nt lds
    s_add_u32 m0, s45, 24576
    s_add_u32 s47, s55, 3145728
    buffer_load_dwordx4 v16, s[36:39], s47 offen offset:0 nt lds
    s_add_u32 m0, s45, 25600
    s_add_u32 s47, s55, 3276800
    buffer_load_dwordx4 v17, s[36:39], s47 offen offset:0 nt lds
    s_add_u32 m0, s45, 26624
    s_add_u32 s47, s55, 3407872
    buffer_load_dwordx4 v18, s[36:39], s47 offen offset:0 nt lds
    s_add_u32 m0, s45, 27648
    s_add_u32 s47, s55, 3538944
    buffer_load_dwordx4 v19, s[36:39], s47 offen offset:0 nt lds
    s_add_u32 m0, s45, 28672
    s_add_u32 s47, s55, 3670016
    buffer_load_dwordx4 v20, s[36:39], s47 offen offset:0 nt lds
    s_add_u32 m0, s45, 29696
    s_add_u32 s47, s55, 3801088
    buffer_load_dwordx4 v21, s[36:39], s47 offen offset:0 nt lds
    s_add_u32 m0, s45, 30720
    s_add_u32 s47, s55, 3932160
    buffer_load_dwordx4 v22, s[36:39], s47 offen offset:0 nt lds
    s_add_u32 m0, s45, 31744
    s_add_u32 s47, s55, 4063232
    buffer_load_dwordx4 v23, s[36:39], s47 offen offset:0 nt lds
    s_lshr_b32 s52, s12, 1
    s_lshl_b32 s52, s52, 8
    s_lshl_b32 s3, s15, 20
    s_add_u32 s52, s52, s3
    s_lshl_b32 s3, s6, 14
    s_add_u32 s52, s52, s3
    s_add_u32 s52, s52, 0
    s_add_u32 s53, s52, 0x10000
    s_add_u32 s54, s52, 0x20000
    s_add_u32 s55, s52, 0x30000
    s_waitcnt vmcnt(20)
    ds_read_b128 a[0:3], v80 offset:0
    ds_read_b128 a[4:7], v81 offset:0
    ds_read_b128 a[8:11], v82 offset:0
    ds_read_b128 a[12:15], v83 offset:0
    ds_read_b128 a[16:19], v80 offset:256
    ds_read_b128 a[20:23], v81 offset:256
    ds_read_b128 a[24:27], v82 offset:256
    ds_read_b128 a[28:31], v83 offset:256
    ds_read_b128 a[32:35], v80 offset:512
    ds_read_b128 a[36:39], v81 offset:512
    ds_read_b128 a[40:43], v82 offset:512
    ds_read_b128 a[44:47], v83 offset:512
    ds_read_b128 a[48:51], v80 offset:768
    ds_read_b128 a[52:55], v81 offset:768
    ds_read_b128 a[56:59], v82 offset:768
    ds_read_b128 a[60:63], v83 offset:768
    s_waitcnt vmcnt(3)
    buffer_load_dwordx4 v[24:27], v6, s[16:19], s48 offen offset:0 sc1
    buffer_load_dwordx4 v[28:31], v6, s[16:19], s48 offen offset:1024 sc1
    buffer_load_dwordx4 v[32:35], v6, s[16:19], s48 offen offset:2048 sc1
    buffer_load_dwordx4 v[36:39], v6, s[16:19], s48 offen offset:3072 sc1
    s_waitcnt vmcnt(4)
    ds_read_b128 a[64:67], v80 offset:16384
    ds_read_b128 a[68:71], v81 offset:16384
    ds_read_b128 a[72:75], v82 offset:16384
    ds_read_b128 a[76:79], v83 offset:16384
    ds_read_b128 a[80:83], v80 offset:16640
    ds_read_b128 a[84:87], v81 offset:16640
    ds_read_b128 a[88:91], v82 offset:16640
    ds_read_b128 a[92:95], v83 offset:16640
    ds_read_b128 a[96:99], v80 offset:16896
    ds_read_b128 a[100:103], v81 offset:16896
    ds_read_b128 a[104:107], v82 offset:16896
    ds_read_b128 a[108:111], v83 offset:16896
    ds_read_b128 a[112:115], v80 offset:17152
    ds_read_b128 a[116:119], v81 offset:17152
    ds_read_b128 a[120:123], v82 offset:17152
    ds_read_b128 a[124:127], v83 offset:17152
    s_mov_b32 s60, 60000
    s_waitcnt vmcnt(0)
    v_xor_b32 v7, s96, v24
    v_bitop3_b32 v7, v7, v25, s97 bitop3:0xf6
    v_bitop3_b32 v7, v7, v26, s98 bitop3:0xf6
    v_bitop3_b32 v7, v7, v27, s99 bitop3:0xf6
    v_bitop3_b32 v7, v7, v28, s96 bitop3:0xf6
    v_bitop3_b32 v7, v7, v29, s97 bitop3:0xf6
    v_bitop3_b32 v7, v7, v30, s98 bitop3:0xf6
    v_bitop3_b32 v7, v7, v31, s99 bitop3:0xf6
    v_bitop3_b32 v7, v7, v32, s96 bitop3:0xf6
    v_bitop3_b32 v7, v7, v33, s97 bitop3:0xf6
    v_bitop3_b32 v7, v7, v34, s98 bitop3:0xf6
    v_bitop3_b32 v7, v7, v35, s99 bitop3:0xf6
    v_bitop3_b32 v7, v7, v36, s96 bitop3:0xf6
    v_bitop3_b32 v7, v7, v37, s97 bitop3:0xf6
    v_bitop3_b32 v7, v7, v38, s98 bitop3:0xf6
    v_bitop3_b32 v7, v7, v39, s99 bitop3:0xf6
    v_and_b32 v7, 0x10001, v7
    v_cmp_ne_u32 vcc, 0, v7
    s_mov_b32 s20, 15
    s_cbranch_vccz Lok_19
Lp_18:
    s_bitcmp0_b32 s20, 0
    s_cbranch_scc1 Ln_20
    v_xor_b32 v7, s96, v24
    v_bitop3_b32 v7, v7, v25, s97 bitop3:0xf6
    v_bitop3_b32 v7, v7, v26, s98 bitop3:0xf6
    v_bitop3_b32 v7, v7, v27, s99 bitop3:0xf6
    v_and_b32 v7, 0x10001, v7
    v_cmp_ne_u32 vcc, 0, v7
    s_cbranch_vccz Lc_21
    buffer_load_dwordx4 v[24:27], v6, s[16:19], s48 offen offset:0 sc1
    s_branch Ln_20
Lc_21:
    s_bitset0_b32 s20, 0
Ln_20:
    s_bitcmp0_b32 s20, 1
    s_cbranch_scc1 Ln_22
    v_xor_b32 v7, s96, v28
    v_bitop3_b32 v7, v7, v29, s97 bitop3:0xf6
    v_bitop3_b32 v7, v7, v30, s98 bitop3:0xf6
    v_bitop3_b32 v7, v7, v31, s99 bitop3:0xf6
    v_and_b32 v7, 0x10001, v7
    v_cmp_ne_u32 vcc, 0, v7
    s_cbranch_vccz Lc_23
    buffer_load_dwordx4 v[28:31], v6, s[16:19], s48 offen offset:1024 sc1
    s_branch Ln_22
Lc_23:
    s_bitset0_b32 s20, 1
Ln_22:
    s_bitcmp0_b32 s20, 2
    s_cbranch_scc1 Ln_24
    v_xor_b32 v7, s96, v32
    v_bitop3_b32 v7, v7, v33, s97 bitop3:0xf6
    v_bitop3_b32 v7, v7, v34, s98 bitop3:0xf6
    v_bitop3_b32 v7, v7, v35, s99 bitop3:0xf6
    v_and_b32 v7, 0x10001, v7
    v_cmp_ne_u32 vcc, 0, v7
    s_cbranch_vccz Lc_25
    buffer_load_dwordx4 v[32:35], v6, s[16:19], s48 offen offset:2048 sc1
    s_branch Ln_24
Lc_25:
    s_bitset0_b32 s20, 2
Ln_24:
    s_bitcmp0_b32 s20, 3
    s_cbranch_scc1 Ln_26
    v_xor_b32 v7, s96, v36
    v_bitop3_b32 v7, v7, v37, s97 bitop3:0xf6
    v_bitop3_b32 v7, v7, v38, s98 bitop3:0xf6
    v_bitop3_b32 v7, v7, v39, s99 bitop3:0xf6
    v_and_b32 v7, 0x10001, v7
    v_cmp_ne_u32 vcc, 0, v7
    s_cbranch_vccz Lc_27
    buffer_load_dwordx4 v[36:39], v6, s[16:19], s48 offen offset:3072 sc1
    s_branch Ln_26
Lc_27:
    s_bitset0_b32 s20, 3
Ln_26:
    s_cmp_eq_u32 s20, 0
    s_cbranch_scc1 Lok_19
    s_waitcnt vmcnt(0)
    s_sub_u32 s60, s60, 1
    s_cbranch_scc0 Lp_18
Lok_19:
    ds_write_b128 v100, v[24:27] offset:0
    ds_write_b128 v101, v[28:31] offset:1024
    ds_write_b128 v102, v[32:35] offset:2048
    ds_write_b128 v103, v[36:39] offset:3072
    s_waitcnt lgkmcnt(0)
    s_barrier
    v_and_b32 v7, 31, v1
    v_lshlrev_b32 v7, 2, v7
    s_lshl_b32 s3, s9, 7
    s_add_u32 s3, s3, 3653632
    buffer_load_dword v125, v7, s[16:19], s3 offen sc1
    ds_read_b128 v[128:131], v84 offset:0
    ds_read_b128 v[132:135], v85 offset:0
    ds_read_b128 v[136:139], v86 offset:0
    ds_read_b128 v[140:143], v87 offset:0
    ds_read_b128 v[144:147], v84 offset:256
    s_waitcnt lgkmcnt(4)
    v_mfma_f32_16x16x32_bf16 v[160:163], a[0:3], v[128:131], 0
    v_mfma_f32_16x16x32_bf16 v[164:167], a[64:67], v[128:131], 0
    ds_read_b128 v[148:151], v85 offset:256
    ds_read_b64_tr_b16 a[128:129], v88 offset:0
    ds_read_b64_tr_b16 a[130:131], v88 offset:16384
    s_waitcnt lgkmcnt(6)
    v_mfma_f32_16x16x32_bf16 v[160:163], a[4:7], v[132:135], v[160:163]
    v_mfma_f32_16x16x32_bf16 v[164:167], a[68:71], v[132:135], v[164:167]
    ds_read_b128 v[152:155], v86 offset:256
    ds_read_b64_tr_b16 a[132:133], v89 offset:0
    ds_read_b64_tr_b16 a[134:135], v89 offset:16384
    s_waitcnt lgkmcnt(8)
    v_mfma_f32_16x16x32_bf16 v[160:163], a[8:11], v[136:139], v[160:163]
    v_mfma_f32_16x16x32_bf16 v[164:167], a[72:75], v[136:139], v[164:167]
    ds_read_b128 v[156:159], v87 offset:256
    ds_read_b64_tr_b16 a[136:137], v90 offset:0
    ds_read_b64_tr_b16 a[138:139], v90 offset:16384
    s_waitcnt lgkmcnt(10)
    v_mfma_f32_16x16x32_bf16 v[160:163], a[12:15], v[140:143], v[160:163]
    v_mfma_f32_16x16x32_bf16 v[164:167], a[76:79], v[140:143], v[164:167]
    ds_read_b128 v[128:131], v84 offset:512
    ds_read_b64_tr_b16 a[140:141], v91 offset:0
    ds_read_b64_tr_b16 a[142:143], v91 offset:16384
    s_waitcnt lgkmcnt(12)
    v_mfma_f32_16x16x32_bf16 v[160:163], a[16:19], v[144:147], v[160:163]
    v_mfma_f32_16x16x32_bf16 v[164:167], a[80:83], v[144:147], v[164:167]
    ds_read_b128 v[132:135], v85 offset:512
    ds_read_b64_tr_b16 a[144:145], v92 offset:0
    ds_read_b64_tr_b16 a[146:147], v92 offset:16384
    s_waitcnt lgkmcnt(14)
    v_mfma_f32_16x16x32_bf16 v[160:163], a[20:23], v[148:151], v[160:163]
    v_mfma_f32_16x16x32_bf16 v[164:167], a[84:87], v[148:151], v[164:167]
    ds_read_b128 v[136:139], v86 offset:512
    ds_read_b64_tr_b16 a[148:149], v93 offset:0
    ds_read_b64_tr_b16 a[150:151], v93 offset:16384
    s_waitcnt lgkmcnt(14)
    v_mfma_f32_16x16x32_bf16 v[160:163], a[24:27], v[152:155], v[160:163]
    v_mfma_f32_16x16x32_bf16 v[164:167], a[88:91], v[152:155], v[164:167]
    ds_read_b128 v[140:143], v87 offset:512
    ds_read_b64_tr_b16 a[152:153], v94 offset:0
    ds_read_b64_tr_b16 a[154:155], v94 offset:16384
    s_waitcnt lgkmcnt(14)
    v_mfma_f32_16x16x32_bf16 v[160:163], a[28:31], v[156:159], v[160:163]
    v_mfma_f32_16x16x32_bf16 v[164:167], a[92:95], v[156:159], v[164:167]
    ds_read_b128 v[144:147], v84 offset:768
    ds_read_b64_tr_b16 a[156:157], v95 offset:0
    ds_read_b64_tr_b16 a[158:159], v95 offset:16384
    s_waitcnt lgkmcnt(14)
    v_mfma_f32_16x16x32_bf16 v[160:163], a[32:35], v[128:131], v[160:163]
    v_mfma_f32_16x16x32_bf16 v[164:167], a[96:99], v[128:131], v[164:167]
    ds_read_b128 v[148:151], v85 offset:768
    ds_read_b64_tr_b16 a[160:161], v88 offset:32768
    ds_read_b64_tr_b16 a[162:163], v88 offset:49152
    s_waitcnt lgkmcnt(14)
    v_mfma_f32_16x16x32_bf16 v[160:163], a[36:39], v[132:135], v[160:163]
    v_mfma_f32_16x16x32_bf16 v[164:167], a[100:103], v[132:135], v[164:167]
    ds_read_b128 v[152:155], v86 offset:768
    ds_read_b64_tr_b16 a[164:165], v89 offset:32768
    ds_read_b64_tr_b16 a[166:167], v89 offset:49152
    s_waitcnt lgkmcnt(14)
    v_mfma_f32_16x16x32_bf16 v[160:163], a[40:43], v[136:139], v[160:163]
    v_mfma_f32_16x16x32_bf16 v[164:167], a[104:107], v[136:139], v[164:167]
    ds_read_b128 v[156:159], v87 offset:768
    ds_read_b64_tr_b16 a[168:169], v90 offset:32768
    ds_read_b64_tr_b16 a[170:171], v90 offset:49152
    s_waitcnt lgkmcnt(14)
    v_mfma_f32_16x16x32_bf16 v[160:163], a[44:47], v[140:143], v[160:163]
    v_mfma_f32_16x16x32_bf16 v[164:167], a[108:111], v[140:143], v[164:167]
    ds_read_b64_tr_b16 a[172:173], v91 offset:32768
    ds_read_b64_tr_b16 a[174:175], v91 offset:49152
    s_waitcnt lgkmcnt(13)
    v_mfma_f32_16x16x32_bf16 v[160:163], a[48:51], v[144:147], v[160:163]
    v_mfma_f32_16x16x32_bf16 v[164:167], a[112:115], v[144:147], v[164:167]
    ds_read_b64_tr_b16 a[176:177], v92 offset:32768
    ds_read_b64_tr_b16 a[178:179], v92 offset:49152
    s_waitcnt lgkmcnt(12)
    v_mfma_f32_16x16x32_bf16 v[160:163], a[52:55], v[148:151], v[160:163]
    v_mfma_f32_16x16x32_bf16 v[164:167], a[116:119], v[148:151], v[164:167]
    ds_read_b64_tr_b16 a[180:181], v93 offset:32768
    ds_read_b64_tr_b16 a[182:183], v93 offset:49152
    s_waitcnt lgkmcnt(11)
    v_mfma_f32_16x16x32_bf16 v[160:163], a[56:59], v[152:155], v[160:163]
    v_mfma_f32_16x16x32_bf16 v[164:167], a[120:123], v[152:155], v[164:167]
    ds_read_b64_tr_b16 a[184:185], v94 offset:32768
    ds_read_b64_tr_b16 a[186:187], v94 offset:49152
    s_waitcnt lgkmcnt(10)
    v_mfma_f32_16x16x32_bf16 v[160:163], a[60:63], v[156:159], v[160:163]
    v_mfma_f32_16x16x32_bf16 v[164:167], a[124:127], v[156:159], v[164:167]
    ds_read_b64_tr_b16 a[188:189], v95 offset:32768
    ds_read_b64_tr_b16 a[190:191], v95 offset:49152
    s_nop 4
    v_max3_f32 v7, v160, v161, v162
    v_max3_f32 v8, v164, v165, v166
    v_max3_f32 v7, v7, v163, v167
    v_max_f32 v7, v7, v8
    v_mov_b32 v8, v7
    s_nop 1
    v_permlane16_swap_b32 v7, v8
    v_max_f32 v7, v7, v8
    v_mov_b32 v8, v7
    s_nop 1
    v_permlane32_swap_b32 v7, v8
    v_max_f32 v7, v7, v8
    ds_write_b32 v104, v7
    s_waitcnt lgkmcnt(0)
    s_barrier
    ds_read_b128 v[168:171], v105
    s_waitcnt lgkmcnt(0)
    v_max3_f32 v144, v168, v169, v170
    v_max_f32 v144, v144, v171
    v_sub_f32 v160, v160, v144
    v_add_u32 v88, 0x10000, v88
    ds_read_b64_tr_b16 a[192:193], v88 offset:0
    ds_read_b64_tr_b16 a[194:195], v88 offset:16384
    v_sub_f32 v161, v161, v144
    v_add_u32 v89, 0x10000, v89
    ds_read_b64_tr_b16 a[196:197], v89 offset:0
    ds_read_b64_tr_b16 a[198:199], v89 offset:16384
    v_sub_f32 v162, v162, v144
    v_add_u32 v90, 0x10000, v90
    ds_read_b64_tr_b16 a[200:201], v90 offset:0
    ds_read_b64_tr_b16 a[202:203], v90 offset:16384
    v_sub_f32 v163, v163, v144
    v_add_u32 v91, 0x10000, v91
    ds_read_b64_tr_b16 a[204:205], v91 offset:0
    ds_read_b64_tr_b16 a[206:207], v91 offset:16384
    v_sub_f32 v164, v164, v144
    v_add_u32 v92, 0x10000, v92
    ds_read_b64_tr_b16 a[208:209], v92 offset:0
    ds_read_b64_tr_b16 a[210:211], v92 offset:16384
    v_sub_f32 v165, v165, v144
    v_add_u32 v93, 0x10000, v93
    ds_read_b64_tr_b16 a[212:213], v93 offset:0
    ds_read_b64_tr_b16 a[214:215], v93 offset:16384
    v_sub_f32 v166, v166, v144
    v_add_u32 v94, 0x10000, v94
    ds_read_b64_tr_b16 a[216:217], v94 offset:0
    ds_read_b64_tr_b16 a[218:219], v94 offset:16384
    v_sub_f32 v167, v167, v144
    v_add_u32 v95, 0x10000, v95
    ds_read_b64_tr_b16 a[220:221], v95 offset:0
    ds_read_b64_tr_b16 a[222:223], v95 offset:16384
    ds_read_b64_tr_b16 a[224:225], v88 offset:32768
    ds_read_b64_tr_b16 a[226:227], v88 offset:49152
    v_exp_f32 v160, v160
    ds_read_b64_tr_b16 a[228:229], v89 offset:32768
    ds_read_b64_tr_b16 a[230:231], v89 offset:49152
    v_exp_f32 v161, v161
    ds_read_b64_tr_b16 a[232:233], v90 offset:32768
    ds_read_b64_tr_b16 a[234:235], v90 offset:49152
    v_exp_f32 v162, v162
    ds_read_b64_tr_b16 a[236:237], v91 offset:32768
    ds_read_b64_tr_b16 a[238:239], v91 offset:49152
    v_exp_f32 v163, v163
    v_cvt_pk_bf16_f32 v168, v160, v161
    ds_read_b64_tr_b16 a[240:241], v92 offset:32768
    ds_read_b64_tr_b16 a[242:243], v92 offset:49152
    v_exp_f32 v164, v164
    ds_read_b64_tr_b16 a[244:245], v93 offset:32768
    ds_read_b64_tr_b16 a[246:247], v93 offset:49152
    v_exp_f32 v165, v165
    v_cvt_pk_bf16_f32 v169, v162, v163
    ds_read_b64_tr_b16 a[248:249], v94 offset:32768
    ds_read_b64_tr_b16 a[250:251], v94 offset:49152
    v_exp_f32 v166, v166
    ds_read_b64_tr_b16 a[252:253], v95 offset:32768
    ds_read_b64_tr_b16 a[254:255], v95 offset:49152
    v_exp_f32 v167, v167
    v_cvt_pk_bf16_f32 v170, v164, v165
    v_cvt_pk_bf16_f32 v171, v166, v167
    ds_write_b128 v106, v[168:171]
    s_waitcnt lgkmcnt(0)
    s_barrier
    ds_read_b128 v[128:131], v107 offset:0
    ds_read_b128 v[132:135], v107 offset:1024
    ds_read_b128 v[136:139], v107 offset:2048
    ds_read_b128 v[140:143], v107 offset:3072
    s_waitcnt lgkmcnt(3)
    v_mfma_f32_16x16x32_bf16 v[176:179], v[128:131], a[128:131], 0
    v_mov_b32 v146, s100
    v_mov_b32 v147, s100
    s_waitcnt lgkmcnt(2)
    v_mfma_f32_16x16x32_bf16 v[176:179], v[132:135], a[160:163], v[176:179]
    s_waitcnt lgkmcnt(1)
    v_mfma_f32_16x16x32_bf16 v[176:179], v[136:139], a[192:195], v[176:179]
    s_waitcnt lgkmcnt(0)
    v_mfma_f32_16x16x32_bf16 v[176:179], v[140:143], a[224:227], v[176:179]
    v_mfma_f32_16x16x32_bf16 v[180:183], v[128:131], a[132:135], 0
    v_mfma_f32_16x16x32_bf16 v[180:183], v[132:135], a[164:167], v[180:183]
    v_mfma_f32_16x16x32_bf16 v[180:183], v[136:139], a[196:199], v[180:183]
    v_mfma_f32_16x16x32_bf16 v[180:183], v[140:143], a[228:231], v[180:183]
    v_mfma_f32_16x16x32_bf16 v[172:175], v[128:131], v[112:115], 0
    v_mfma_f32_16x16x32_bf16 v[172:175], v[132:135], v[112:115], v[172:175]
    v_mfma_f32_16x16x32_bf16 v[172:175], v[136:139], v[112:115], v[172:175]
    v_mfma_f32_16x16x32_bf16 v[172:175], v[140:143], v[112:115], v[172:175]
    s_nop 3
    v_perm_b32 v208, v180, v176, v252
    v_perm_b32 v212, v181, v177, v252
    v_mfma_f32_16x16x32_bf16 v[184:187], v[128:131], a[136:139], 0
    v_perm_b32 v216, v182, v178, v252
    v_perm_b32 v220, v183, v179, v252
    v_mfma_f32_16x16x32_bf16 v[184:187], v[132:135], a[168:171], v[184:187]
    v_bitop3_b32 v176, v208, s96, v255 bitop3:0x28
    v_bitop3_b32 v177, v212, s96, v255 bitop3:0x28
    v_mfma_f32_16x16x32_bf16 v[184:187], v[136:139], a[200:203], v[184:187]
    v_bitop3_b32 v178, v216, s96, v255 bitop3:0x28
    v_bitop3_b32 v179, v220, s96, v255 bitop3:0x28
    v_mfma_f32_16x16x32_bf16 v[184:187], v[140:143], a[232:235], v[184:187]
    v_add_u32 v208, v208, v176
    v_add_u32 v212, v212, v177
    v_mfma_f32_16x16x32_bf16 v[188:191], v[128:131], a[140:143], 0
    v_add_u32 v216, v216, v178
    v_add_u32 v220, v220, v179
    v_mfma_f32_16x16x32_bf16 v[188:191], v[132:135], a[172:175], v[188:191]
    v_cndmask_b32 v145, v172, v173, s[62:63]
    v_cndmask_b32 v148, v174, v175, s[62:63]
    v_mfma_f32_16x16x32_bf16 v[188:191], v[136:139], a[204:207], v[188:191]
    v_cndmask_b32 v145, v145, v148, s[22:23]
    buffer_store_dwordx4 v[144:147], v109, s[16:19], s56 offen sc1
    v_mfma_f32_16x16x32_bf16 v[188:191], v[140:143], a[236:239], v[188:191]
    v_mfma_f32_16x16x32_bf16 v[192:195], v[128:131], a[144:147], 0
    v_mfma_f32_16x16x32_bf16 v[192:195], v[132:135], a[176:179], v[192:195]
    v_mfma_f32_16x16x32_bf16 v[192:195], v[136:139], a[208:211], v[192:195]
    v_mfma_f32_16x16x32_bf16 v[192:195], v[140:143], a[240:243], v[192:195]
    s_nop 3
    v_perm_b32 v209, v188, v184, v252
    v_perm_b32 v213, v189, v185, v252
    v_mfma_f32_16x16x32_bf16 v[196:199], v[128:131], a[148:151], 0
    v_perm_b32 v217, v190, v186, v252
    v_perm_b32 v221, v191, v187, v252
    v_mfma_f32_16x16x32_bf16 v[196:199], v[132:135], a[180:183], v[196:199]
    v_bitop3_b32 v184, v209, s97, v255 bitop3:0x28
    v_bitop3_b32 v185, v213, s97, v255 bitop3:0x28
    v_mfma_f32_16x16x32_bf16 v[196:199], v[136:139], a[212:215], v[196:199]
    v_bitop3_b32 v186, v217, s97, v255 bitop3:0x28
    v_bitop3_b32 v187, v221, s97, v255 bitop3:0x28
    v_mfma_f32_16x16x32_bf16 v[196:199], v[140:143], a[244:247], v[196:199]
    v_add_u32 v209, v209, v184
    v_add_u32 v213, v213, v185
    v_mfma_f32_16x16x32_bf16 v[200:203], v[128:131], a[152:155], 0
    v_add_u32 v217, v217, v186
    v_add_u32 v221, v221, v187
    v_mfma_f32_16x16x32_bf16 v[200:203], v[132:135], a[184:187], v[200:203]
    v_mfma_f32_16x16x32_bf16 v[200:203], v[136:139], a[216:219], v[200:203]
    v_mfma_f32_16x16x32_bf16 v[200:203], v[140:143], a[248:251], v[200:203]
    v_perm_b32 v210, v196, v192, v252
    v_perm_b32 v214, v197, v193, v252
    v_mfma_f32_16x16x32_bf16 v[204:207], v[128:131], a[156:159], 0
    v_perm_b32 v218, v198, v194, v252
    v_perm_b32 v222, v199, v195, v252
    v_mfma_f32_16x16x32_bf16 v[204:207], v[132:135], a[188:191], v[204:207]
    v_bitop3_b32 v192, v210, s98, v255 bitop3:0x28
    v_bitop3_b32 v193, v214, s98, v255 bitop3:0x28
    v_mfma_f32_16x16x32_bf16 v[204:207], v[136:139], a[220:223], v[204:207]
    v_bitop3_b32 v194, v218, s98, v255 bitop3:0x28
    v_bitop3_b32 v195, v222, s98, v255 bitop3:0x28
    v_mfma_f32_16x16x32_bf16 v[204:207], v[140:143], a[252:255], v[204:207]
    v_add_u32 v210, v210, v192
    v_add_u32 v214, v214, v193
    v_add_u32 v218, v218, v194
    v_add_u32 v222, v222, v195
    s_nop 3
    v_perm_b32 v211, v204, v200, v252
    v_perm_b32 v215, v205, v201, v252
    v_perm_b32 v219, v206, v202, v252
    v_perm_b32 v223, v207, v203, v252
    v_bitop3_b32 v200, v211, s99, v255 bitop3:0x28
    v_bitop3_b32 v201, v215, s99, v255 bitop3:0x28
    v_bitop3_b32 v202, v219, s99, v255 bitop3:0x28
    v_bitop3_b32 v203, v223, s99, v255 bitop3:0x28
    v_add_u32 v211, v211, v200
    v_add_u32 v215, v215, v201
    v_add_u32 v219, v219, v202
    v_add_u32 v223, v223, v203
    buffer_store_dwordx4 v[208:211], v108, s[16:19], s52 offen sc1
    buffer_store_dwordx4 v[212:215], v108, s[16:19], s53 offen sc1
    buffer_store_dwordx4 v[216:219], v108, s[16:19], s54 offen sc1
    buffer_store_dwordx4 v[220:223], v108, s[16:19], s55 offen sc1
    s_lshl_b32 s48, s12, 14
    s_lshl_b32 s3, s6, 12
    s_add_u32 s48, s48, s3
    s_lshl_b32 s3, s6, 12
    s_add_u32 s48, s48, 0
    s_add_u32 s52, s3, 81920
    v_lshlrev_b32 v100, 9, v1
    s_lshl_b32 s53, s7, 4
    s_add_u32 s53, s53, 3604480
    s_lshl_b32 s3, s6, 7
    s_add_u32 s3, s3, 147456
    v_lshl_add_u32 v98, v1, 1, s3
    v_and_b32 v7, 1, v2
    v_lshlrev_b32 v8, 6, v7
    v_lshl_add_u32 v8, v3, 3, v8
    v_add_u32 v99, s3, v8
    v_lshlrev_b32 v8, 5, v3
    v_xor_b32 v101, v8, v6
    v_add_u32 v101, s52, v101
    v_xor_b32 v102, 0x80, v101
    v_lshl_add_u32 v10, v3, 2, v4
    v_lshl_add_u32 v8, v10, 8, v249
    v_add_u32 v88, 81920, v8
    v_xor_b32 v89, 32, v88
    v_xor_b32 v90, 64, v88
    v_xor_b32 v91, 96, v88
    v_xor_b32 v92, 128, v88
    v_xor_b32 v93, 160, v88
    v_xor_b32 v94, 192, v88
    v_xor_b32 v95, 224, v88
    s_lshr_b32 s56, s12, 1
    s_lshl_b32 s3, s56, 5
    v_bfe_u32 v7, v1, 2, 1
    v_mul_u32_u24 v7, 1152, v7
    v_add3_u32 v240, v7, v5, s3
    buffer_load_dwordx2 v[242:243], v240, s[24:27], 0 offen
    v_accvgpr_write_b32 a0, v40
    v_accvgpr_write_b32 a1, v41
    v_accvgpr_write_b32 a2, v42
    v_accvgpr_write_b32 a3, v43
    v_accvgpr_write_b32 a4, v44
    v_accvgpr_write_b32 a5, v45
    v_accvgpr_write_b32 a6, v46
    v_accvgpr_write_b32 a7, v47
    v_accvgpr_write_b32 a8, v48
    v_accvgpr_write_b32 a9, v49
    v_accvgpr_write_b32 a10, v50
    v_accvgpr_write_b32 a11, v51
    v_accvgpr_write_b32 a12, v52
    v_accvgpr_write_b32 a13, v53
    v_accvgpr_write_b32 a14, v54
    v_accvgpr_write_b32 a15, v55
    v_accvgpr_write_b32 a16, v56
    v_accvgpr_write_b32 a17, v57
    v_accvgpr_write_b32 a18, v58
    v_accvgpr_write_b32 a19, v59
    v_accvgpr_write_b32 a20, v60
    v_accvgpr_write_b32 a21, v61
    v_accvgpr_write_b32 a22, v62
    v_accvgpr_write_b32 a23, v63
    v_accvgpr_write_b32 a24, v64
    v_accvgpr_write_b32 a25, v65
    v_accvgpr_write_b32 a26, v66
    v_accvgpr_write_b32 a27, v67
    v_accvgpr_write_b32 a28, v68
    v_accvgpr_write_b32 a29, v69
    v_accvgpr_write_b32 a30, v70
    v_accvgpr_write_b32 a31, v71
    s_waitcnt vmcnt(0)
    buffer_load_dwordx3 v[40:42], v100, s[16:19], s53 offen sc1
    s_mov_b32 s60, 60000
    s_waitcnt vmcnt(0)
Lp_28:
    v_xor_b32 v7, s100, v42
    v_cmp_ne_u32 vcc, 0, v7
    s_cbranch_vccz Lok_29
    s_sub_u32 s60, s60, 1
    s_cbranch_scc1 Lok_29
    buffer_load_dwordx3 v[40:42], v100, s[16:19], s53 offen sc1
    s_waitcnt vmcnt(0)
    s_branch Lp_28
Lok_29:
    buffer_load_dwordx4 v[24:27], v6, s[16:19], s48 offen offset:0 sc1
    buffer_load_dwordx4 v[28:31], v6, s[16:19], s48 offen offset:1024 sc1
    buffer_load_dwordx4 v[32:35], v6, s[16:19], s48 offen offset:2048 sc1
    buffer_load_dwordx4 v[36:39], v6, s[16:19], s48 offen offset:3072 sc1
    v_mov_b32 v7, v40
    s_nop 1
    v_max_f32_dpp v7, v7, v7 row_ror:8 row_mask:0xf bank_mask:0xf
    s_nop 1
    v_max_f32_dpp v7, v7, v7 row_ror:4 row_mask:0xf bank_mask:0xf
    s_nop 1
    v_max_f32_dpp v7, v7, v7 row_ror:2 row_mask:0xf bank_mask:0xf
    s_nop 1
    v_max_f32_dpp v7, v7, v7 row_ror:1 row_mask:0xf bank_mask:0xf
    v_mov_b32 v8, v7
    s_nop 1
    v_permlane16_swap_b32 v7, v8
    v_max_f32 v7, v7, v8
    v_sub_f32 v7, v40, v7
    v_exp_f32 v10, v7
    s_nop 0
    v_mul_f32 v7, v10, v41
    s_nop 1
    v_add_f32_dpp v7, v7, v7 row_ror:8 row_mask:0xf bank_mask:0xf
    s_nop 1
    v_add_f32_dpp v7, v7, v7 row_ror:4 row_mask:0xf bank_mask:0xf
    s_nop 1
    v_add_f32_dpp v7, v7, v7 row_ror:2 row_mask:0xf bank_mask:0xf
    s_nop 1
    v_add_f32_dpp v7, v7, v7 row_ror:1 row_mask:0xf bank_mask:0xf
    v_mov_b32 v8, v7
    s_nop 1
    v_permlane16_swap_b32 v7, v8
    v_add_f32 v7, v7, v8
    v_rcp_f32 v7, v7
    s_nop 0
    v_mul_f32 v7, v7, v10
    v_cvt_pk_bf16_f32 v7, v7, v7
    ds_write_b16 v98, v7
    s_waitcnt lgkmcnt(0)
    ds_read2_b64 v[44:47], v99 offset0:0 offset1:4
    s_waitcnt lgkmcnt(0)
    v_cndmask_b32 v68, v44, 0, s[62:63]
    v_cndmask_b32 v72, 0, v44, s[62:63]
    v_cndmask_b32 v69, v45, 0, s[62:63]
    v_cndmask_b32 v73, 0, v45, s[62:63]
    v_cndmask_b32 v70, v46, 0, s[62:63]
    v_cndmask_b32 v74, 0, v46, s[62:63]
    v_cndmask_b32 v71, v47, 0, s[62:63]
    v_cndmask_b32 v75, 0, v47, s[62:63]
    s_mov_b32 s60, 60000
    s_waitcnt vmcnt(0)
    v_xor_b32 v7, s96, v24
    v_bitop3_b32 v7, v7, v25, s97 bitop3:0xf6
    v_bitop3_b32 v7, v7, v26, s98 bitop3:0xf6
    v_bitop3_b32 v7, v7, v27, s99 bitop3:0xf6
    v_bitop3_b32 v7, v7, v28, s96 bitop3:0xf6
    v_bitop3_b32 v7, v7, v29, s97 bitop3:0xf6
    v_bitop3_b32 v7, v7, v30, s98 bitop3:0xf6
    v_bitop3_b32 v7, v7, v31, s99 bitop3:0xf6
    v_bitop3_b32 v7, v7, v32, s96 bitop3:0xf6
    v_bitop3_b32 v7, v7, v33, s97 bitop3:0xf6
    v_bitop3_b32 v7, v7, v34, s98 bitop3:0xf6
    v_bitop3_b32 v7, v7, v35, s99 bitop3:0xf6
    v_bitop3_b32 v7, v7, v36, s96 bitop3:0xf6
    v_bitop3_b32 v7, v7, v37, s97 bitop3:0xf6
    v_bitop3_b32 v7, v7, v38, s98 bitop3:0xf6
    v_bitop3_b32 v7, v7, v39, s99 bitop3:0xf6
    v_and_b32 v7, 0x10001, v7
    v_cmp_ne_u32 vcc, 0, v7
    s_mov_b32 s20, 15
    s_cbranch_vccz Lok_31
Lp_30:
    s_bitcmp0_b32 s20, 0
    s_cbranch_scc1 Ln_32
    v_xor_b32 v7, s96, v24
    v_bitop3_b32 v7, v7, v25, s97 bitop3:0xf6
    v_bitop3_b32 v7, v7, v26, s98 bitop3:0xf6
    v_bitop3_b32 v7, v7, v27, s99 bitop3:0xf6
    v_and_b32 v7, 0x10001, v7
    v_cmp_ne_u32 vcc, 0, v7
    s_cbranch_vccz Lc_33
    buffer_load_dwordx4 v[24:27], v6, s[16:19], s48 offen offset:0 sc1
    s_branch Ln_32
Lc_33:
    s_bitset0_b32 s20, 0
Ln_32:
    s_bitcmp0_b32 s20, 1
    s_cbranch_scc1 Ln_34
    v_xor_b32 v7, s96, v28
    v_bitop3_b32 v7, v7, v29, s97 bitop3:0xf6
    v_bitop3_b32 v7, v7, v30, s98 bitop3:0xf6
    v_bitop3_b32 v7, v7, v31, s99 bitop3:0xf6
    v_and_b32 v7, 0x10001, v7
    v_cmp_ne_u32 vcc, 0, v7
    s_cbranch_vccz Lc_35
    buffer_load_dwordx4 v[28:31], v6, s[16:19], s48 offen offset:1024 sc1
    s_branch Ln_34
Lc_35:
    s_bitset0_b32 s20, 1
Ln_34:
    s_bitcmp0_b32 s20, 2
    s_cbranch_scc1 Ln_36
    v_xor_b32 v7, s96, v32
    v_bitop3_b32 v7, v7, v33, s97 bitop3:0xf6
    v_bitop3_b32 v7, v7, v34, s98 bitop3:0xf6
    v_bitop3_b32 v7, v7, v35, s99 bitop3:0xf6
    v_and_b32 v7, 0x10001, v7
    v_cmp_ne_u32 vcc, 0, v7
    s_cbranch_vccz Lc_37
    buffer_load_dwordx4 v[32:35], v6, s[16:19], s48 offen offset:2048 sc1
    s_branch Ln_36
Lc_37:
    s_bitset0_b32 s20, 2
Ln_36:
    s_bitcmp0_b32 s20, 3
    s_cbranch_scc1 Ln_38
    v_xor_b32 v7, s96, v36
    v_bitop3_b32 v7, v7, v37, s97 bitop3:0xf6
    v_bitop3_b32 v7, v7, v38, s98 bitop3:0xf6
    v_bitop3_b32 v7, v7, v39, s99 bitop3:0xf6
    v_and_b32 v7, 0x10001, v7
    v_cmp_ne_u32 vcc, 0, v7
    s_cbranch_vccz Lc_39
    buffer_load_dwordx4 v[36:39], v6, s[16:19], s48 offen offset:3072 sc1
    s_branch Ln_38
Lc_39:
    s_bitset0_b32 s20, 3
Ln_38:
    s_cmp_eq_u32 s20, 0
    s_cbranch_scc1 Lok_31
    s_waitcnt vmcnt(0)
    s_sub_u32 s60, s60, 1
    s_cbranch_scc0 Lp_30
Lok_31:
    ds_write_b128 v101, v[24:27] offset:0
    ds_write_b128 v102, v[28:31] offset:1024
    ds_write_b128 v101, v[32:35] offset:2048
    ds_write_b128 v102, v[36:39] offset:3072
    s_waitcnt lgkmcnt(0)
    s_barrier
    ds_read_b64_tr_b16 v[128:129], v88 offset:0
    ds_read_b64_tr_b16 v[130:131], v88 offset:4096
    ds_read_b64_tr_b16 v[132:133], v88 offset:8192
    ds_read_b64_tr_b16 v[134:135], v88 offset:12288
    ds_read_b64_tr_b16 v[136:137], v89 offset:0
    ds_read_b64_tr_b16 v[138:139], v89 offset:4096
    ds_read_b64_tr_b16 v[140:141], v89 offset:8192
    ds_read_b64_tr_b16 v[142:143], v89 offset:12288
    ds_read_b64_tr_b16 v[144:145], v90 offset:0
    ds_read_b64_tr_b16 v[146:147], v90 offset:4096
    ds_read_b64_tr_b16 v[148:149], v90 offset:8192
    ds_read_b64_tr_b16 v[150:151], v90 offset:12288
    s_waitcnt lgkmcnt(8)
    v_mfma_f32_16x16x32_bf16 v[192:195], v[128:131], v[68:71], 0
    v_mfma_f32_16x16x32_bf16 v[192:195], v[132:135], v[72:75], v[192:195]
    ds_read_b64_tr_b16 v[152:153], v91 offset:0
    ds_read_b64_tr_b16 v[154:155], v91 offset:4096
    ds_read_b64_tr_b16 v[156:157], v91 offset:8192
    ds_read_b64_tr_b16 v[158:159], v91 offset:12288
    s_waitcnt lgkmcnt(8)
    v_mfma_f32_16x16x32_bf16 v[196:199], v[136:139], v[68:71], 0
    v_mfma_f32_16x16x32_bf16 v[196:199], v[140:143], v[72:75], v[196:199]
    ds_read_b64_tr_b16 v[160:161], v92 offset:0
    ds_read_b64_tr_b16 v[162:163], v92 offset:4096
    ds_read_b64_tr_b16 v[164:165], v92 offset:8192
    ds_read_b64_tr_b16 v[166:167], v92 offset:12288
    s_waitcnt lgkmcnt(8)
    v_mfma_f32_16x16x32_bf16 v[200:203], v[144:147], v[68:71], 0
    v_mfma_f32_16x16x32_bf16 v[200:203], v[148:151], v[72:75], v[200:203]
    ds_read_b64_tr_b16 v[168:169], v93 offset:0
    ds_read_b64_tr_b16 v[170:171], v93 offset:4096
    ds_read_b64_tr_b16 v[172:173], v93 offset:8192
    ds_read_b64_tr_b16 v[174:175], v93 offset:12288
    v_cvt_pk_bf16_f32 v48, v192, v193
    v_cvt_pk_bf16_f32 v49, v194, v195
    s_waitcnt lgkmcnt(8)
    v_mfma_f32_16x16x32_bf16 v[204:207], v[152:155], v[68:71], 0
    v_mfma_f32_16x16x32_bf16 v[204:207], v[156:159], v[72:75], v[204:207]
    ds_read_b64_tr_b16 v[176:177], v94 offset:0
    ds_read_b64_tr_b16 v[178:179], v94 offset:4096
    ds_read_b64_tr_b16 v[180:181], v94 offset:8192
    ds_read_b64_tr_b16 v[182:183], v94 offset:12288
    v_cvt_pk_bf16_f32 v50, v196, v197
    v_cvt_pk_bf16_f32 v51, v198, v199
    s_waitcnt lgkmcnt(8)
    v_mfma_f32_16x16x32_bf16 v[208:211], v[160:163], v[68:71], 0
    v_mfma_f32_16x16x32_bf16 v[208:211], v[164:167], v[72:75], v[208:211]
    ds_read_b64_tr_b16 v[184:185], v95 offset:0
    ds_read_b64_tr_b16 v[186:187], v95 offset:4096
    ds_read_b64_tr_b16 v[188:189], v95 offset:8192
    ds_read_b64_tr_b16 v[190:191], v95 offset:12288
    v_cvt_pk_bf16_f32 v52, v200, v201
    v_cvt_pk_bf16_f32 v53, v202, v203
    s_waitcnt lgkmcnt(8)
    v_mfma_f32_16x16x32_bf16 v[212:215], v[168:171], v[68:71], 0
    v_mfma_f32_16x16x32_bf16 v[212:215], v[172:175], v[72:75], v[212:215]
    v_cvt_pk_bf16_f32 v54, v204, v205
    v_cvt_pk_bf16_f32 v55, v206, v207
    s_waitcnt lgkmcnt(4)
    v_mfma_f32_16x16x32_bf16 v[216:219], v[176:179], v[68:71], 0
    v_mfma_f32_16x16x32_bf16 v[216:219], v[180:183], v[72:75], v[216:219]
    v_cvt_pk_bf16_f32 v56, v208, v209
    v_cvt_pk_bf16_f32 v57, v210, v211
    s_waitcnt lgkmcnt(0)
    v_mfma_f32_16x16x32_bf16 v[220:223], v[184:187], v[68:71], 0
    v_mfma_f32_16x16x32_bf16 v[220:223], v[188:191], v[72:75], v[220:223]
    v_cvt_pk_bf16_f32 v58, v212, v213
    v_cvt_pk_bf16_f32 v59, v214, v215
    v_mfma_f32_16x16x32_bf16 v[224:227], a[0:3], v[48:51], 0
    v_mfma_f32_16x16x32_bf16 v[228:231], a[16:19], v[48:51], 0
    v_mfma_f32_16x16x32_bf16 v[224:227], a[4:7], v[52:55], v[224:227]
    v_mfma_f32_16x16x32_bf16 v[228:231], a[20:23], v[52:55], v[228:231]
    v_mfma_f32_16x16x32_bf16 v[224:227], a[8:11], v[56:59], v[224:227]
    v_mfma_f32_16x16x32_bf16 v[228:231], a[24:27], v[56:59], v[228:231]
    v_cvt_pk_bf16_f32 v60, v216, v217
    v_cvt_pk_bf16_f32 v61, v218, v219
    v_cvt_pk_bf16_f32 v62, v220, v221
    v_cvt_pk_bf16_f32 v63, v222, v223
    s_nop 1
    v_mfma_f32_16x16x32_bf16 v[224:227], a[12:15], v[60:63], v[224:227]
    v_mfma_f32_16x16x32_bf16 v[228:231], a[28:31], v[60:63], v[228:231]
    s_nop 7
    v_cndmask_b32 v224, v224, v228, s[22:23]
    v_cndmask_b32 v225, v225, v229, s[22:23]
    v_cndmask_b32 v226, v226, v230, s[22:23]
    v_cndmask_b32 v227, v227, v231, s[22:23]
    v_and_or_b32 v224, v224, v254, v236
    v_and_or_b32 v225, v225, v254, v237
    v_and_or_b32 v226, v226, v254, v238
    v_and_or_b32 v227, v227, v254, v239
    buffer_store_dwordx4 v[224:227], v247, s[16:19], s50 offen
    s_getreg_b32 s3, hwreg(HW_REG_XCC_ID, 0, 4)
    s_add_u32 s3, s3, s100
    v_cmp_ne_u32 vcc, s3, v125
    s_cbranch_vccz Lx_40
    s_add_u32 s3, s50, 720896
    buffer_store_dwordx4 v[224:227], v247, s[16:19], s3 offen sc1
Lx_40:
    s_lshl_b32 s3, s12, 2
    s_add_u32 s3, s3, s6
    s_cmp_eq_u32 s3, 511
    s_cbranch_scc0 Lne_41
    s_xor_b32 s53, s53, 0x100
    buffer_load_dwordx3 v[40:42], v100, s[16:19], s53 offen sc1
    s_mov_b32 s60, 60000
    s_waitcnt vmcnt(0)
Lp_42:
    v_xor_b32 v7, s100, v42
    v_cmp_ne_u32 vcc, 0, v7
    s_cbranch_vccz Lok_43
    s_sub_u32 s60, s60, 1
    s_cbranch_scc1 Lok_43
    buffer_load_dwordx3 v[40:42], v100, s[16:19], s53 offen sc1
    s_waitcnt vmcnt(0)
    s_branch Lp_42
Lok_43:
    s_mov_b64 exec, 1
    v_mov_b32 v7, 4128768
    v_mov_b32 v10, s100
    v_mov_b32 v11, s61
    buffer_store_dwordx2 v[10:11], v7, s[16:19], 0 offen sc1
Lne_41:
    s_and_b32 s3, s12, 1
    s_or_b32 s3, s3, 0
    s_cbranch_scc1 L_gb_exit
    s_cmp_ge_u32 s12, 72
    s_cbranch_scc1 L_gb_exit
    s_lshl_b32 s44, s56, 12
    s_add_u32 s45, s44, 3833856
    s_add_u32 s44, s44, 3670016
    s_lshl_b32 s3, s6, 10
    s_add_u32 s44, s44, s3
    s_add_u32 s45, s45, s3
    s_add_u32 s3, s3, 148480
    v_add_u32 v10, s3, v6
    v_add_u32 v11, 148480, v6
    buffer_load_dwordx4 v[128:131], v6, s[16:19], s44 offen sc1
    buffer_load_dwordx4 v[144:147], v6, s[16:19], s45 offen sc1
    s_mov_b32 s60, 60000
    s_waitcnt vmcnt(0)
    v_xor_b32 v7, v236, v128
    v_bitop3_b32 v7, v7, v129, v237 bitop3:0xf6
    v_bitop3_b32 v7, v7, v130, v238 bitop3:0xf6
    v_bitop3_b32 v7, v7, v131, v239 bitop3:0xf6
    v_bitop3_b32 v7, v7, v144, v236 bitop3:0xf6
    v_bitop3_b32 v7, v7, v145, v237 bitop3:0xf6
    v_bitop3_b32 v7, v7, v146, v238 bitop3:0xf6
    v_bitop3_b32 v7, v7, v147, v239 bitop3:0xf6
    v_and_b32 v7, 0xff, v7
    v_cmp_ne_u32 vcc, 0, v7
    s_mov_b32 s20, 3
    s_cbranch_vccz Lok_45
Lp_44:
    s_bitcmp0_b32 s20, 0
    s_cbranch_scc1 Ln_46
    v_xor_b32 v7, v236, v128
    v_bitop3_b32 v7, v7, v129, v237 bitop3:0xf6
    v_bitop3_b32 v7, v7, v130, v238 bitop3:0xf6
    v_bitop3_b32 v7, v7, v131, v239 bitop3:0xf6
    v_and_b32 v7, 0xff, v7
    v_cmp_ne_u32 vcc, 0, v7
    s_cbranch_vccz Lc_47
    buffer_load_dwordx4 v[128:131], v6, s[16:19], s44 offen sc1
    s_branch Ln_46
Lc_47:
    s_bitset0_b32 s20, 0
Ln_46:
    s_bitcmp0_b32 s20, 1
    s_cbranch_scc1 Ln_48
    v_xor_b32 v7, v236, v144
    v_bitop3_b32 v7, v7, v145, v237 bitop3:0xf6
    v_bitop3_b32 v7, v7, v146, v238 bitop3:0xf6
    v_bitop3_b32 v7, v7, v147, v239 bitop3:0xf6
    v_and_b32 v7, 0xff, v7
    v_cmp_ne_u32 vcc, 0, v7
    s_cbranch_vccz Lc_49
    buffer_load_dwordx4 v[144:147], v6, s[16:19], s45 offen sc1
    s_branch Ln_48
Lc_49:
    s_bitset0_b32 s20, 1
Ln_48:
    s_cmp_eq_u32 s20, 0
    s_cbranch_scc1 Lok_45
    s_waitcnt vmcnt(0)
    s_sub_u32 s60, s60, 1
    s_cbranch_scc0 Lp_44
Lok_45:
    v_permlane32_swap_b32 v128, v144
    v_permlane32_swap_b32 v129, v145
    v_permlane32_swap_b32 v130, v146
    v_permlane32_swap_b32 v131, v147
    v_pk_add_f32 v[128:129], v[128:129], v[144:145]
    v_pk_add_f32 v[130:131], v[130:131], v[146:147]
    ds_write_b128 v10, v[128:131]
    s_waitcnt lgkmcnt(0)
    s_barrier
    s_cmp_eq_u32 s6, 0
    s_cbranch_scc0 L_gb_exit
    ds_read_b128 v[132:135], v11 offset:1024
    ds_read_b128 v[136:139], v11 offset:2048
    ds_read_b128 v[140:143], v11 offset:3072
    s_waitcnt lgkmcnt(0)
    v_pk_add_f32 v[128:129], v[128:129], v[132:133]
    v_pk_add_f32 v[136:137], v[136:137], v[140:141]
    v_pk_add_f32 v[130:131], v[130:131], v[134:135]
    v_pk_add_f32 v[138:139], v[138:139], v[142:143]
    v_pk_add_f32 v[128:129], v[128:129], v[136:137]
    v_pk_add_f32 v[130:131], v[130:131], v[138:139]
    s_nop 1
    v_permlane16_swap_b32 v128, v130
    v_permlane16_swap_b32 v129, v131
    v_pk_add_f32 v[128:129], v[128:129], v[130:131]
    s_nop 1
    v_add_f32_dpp v128, v128, v128 row_ror:8 row_mask:0xf bank_mask:0xf
    v_add_f32_dpp v129, v129, v129 row_ror:8 row_mask:0xf bank_mask:0xf
    v_cvt_pk_bf16_f32 v160, v128, v129
    v_mov_b32 v161, v160
    s_nop 1
    v_permlane32_swap_b32 v160, v161
    v_lshlrev_b32 v144, 16, v161
    v_and_b32 v145, 0xffff0000, v161
    v_mul_f32 v130, 0xbfb8aa3b, v144
    v_mul_f32 v131, 0xbfb8aa3b, v145
    v_exp_f32 v130, v130
    v_exp_f32 v131, v131
    v_lshlrev_b32 v128, 16, v160
    v_and_b32 v129, 0xffff0000, v160
    v_add_f32 v130, 1.0, v130
    v_add_f32 v131, 1.0, v131
    v_rcp_f32 v130, v130
    v_rcp_f32 v131, v131
    v_and_b32 v7, 1, v3
    v_cmp_ne_u32 vcc, 0, v7
    v_mul_f32 v144, v144, v130
    v_mul_f32 v145, v145, v131
    v_cndmask_b32 v242, v242, v243, vcc
    v_cvt_pk_bf16_f32 v160, v144, v145
    v_lshl_add_u32 v240, v7, 2, v240
    v_lshlrev_b32 v144, 16, v160
    v_and_b32 v145, 0xffff0000, v160
    v_mul_f32 v144, v144, v128
    v_mul_f32 v145, v145, v129
    v_lshlrev_b32 v128, 16, v242
    v_cvt_pk_bf16_f32 v160, v144, v145
    v_and_b32 v129, 0xffff0000, v242
    v_lshlrev_b32 v144, 16, v160
    v_and_b32 v145, 0xffff0000, v160
    v_add_f32 v144, v144, v128
    v_add_f32 v145, v145, v129
    v_cvt_pk_bf16_f32 v160, v144, v145
    s_mov_b64 exec, 0x00ff00ff
    buffer_store_dword v160, v240, s[28:31], 0 offen
L_gb_exit:
L_end:
    s_endpgm
.section .rodata,"a"
.p2align 6
.amdhsa_kernel recurrent_scan__compressed_kv_cla__geglu_ffn__decode_kernel
  .amdhsa_next_free_vgpr 512
  .amdhsa_next_free_sgpr 102
  .amdhsa_accum_offset 256
  .amdhsa_group_segment_fixed_size 0
  .amdhsa_kernarg_size 104
  .amdhsa_user_sgpr_count 2
  .amdhsa_user_sgpr_kernarg_segment_ptr 1
  .amdhsa_system_sgpr_workgroup_id_x 1
  .amdhsa_float_denorm_mode_32 3
.end_amdhsa_kernel
```
